```python
import torch

def _softmax(x, axis=-1):
    return torch.softmax(x, dim=axis)
def _gelu(x):
    return torch.nn.functional.gelu(x, approximate="tanh")
def _silu(x):
    return torch.nn.functional.silu(x)
def _sigmoid(x):
    return torch.sigmoid(x)
def _layernorm(x, axis=-1, eps=1e-5):
    m = x.mean(dim=axis, keepdim=True)
    v = x.var(dim=axis, keepdim=True, unbiased=False)
    return (x - m) / torch.sqrt(v + eps)
def _scatter_add(tgt, idx, src, axis=0):
    return tgt.clone().index_add_(axis, idx, src)
def _segment_sum(src, seg, n):
    out = torch.zeros((n,) + src.shape[1:], dtype=src.dtype)
    return out.index_add_(0, seg, src)
def _pad(x, pw):
    flat = tuple(v for pair in reversed(pw) for v in pair)
    return torch.nn.functional.pad(x, flat)

kernel_name = 'concat_heads__sliding_local_dilated__linear_attn_block__prompt'

def setup_inputs():

    _w = (lambda a: (lambda t: t.to(torch.bfloat16) if t.is_floating_point() else t)(torch.as_tensor(a)))
    def _A_setup():
        B, S, D = 1, 2048, 512
        return {
            "x": _w((lambda *s: torch.randn(*s, dtype=torch.bfloat16) * 0.2)(B, S, D)),
            "wqkv": _w((lambda *s: torch.randn(*s, dtype=torch.bfloat16) * 0.2)(D, 3 * D)),
            "wo": _w((lambda *s: torch.randn(*s, dtype=torch.bfloat16) * 0.05)(D, D)),
        }
    _A_in = _A_setup()

    def _B_setup():
        B, S, D = 1, 2048, 512
        return {
            "x": _w((lambda *s: torch.randn(*s, dtype=torch.bfloat16) * 0.05)(B, S, D)),
            "wqkv": _w((lambda *s: torch.randn(*s, dtype=torch.bfloat16) * 1.6)(D, 3 * D)),
            "wo": _w((lambda *s: torch.randn(*s, dtype=torch.bfloat16) * 0.8)(D, D)),
        }
    _B_in = _B_setup()

    return {
        "A_x": _A_in["x"],
        "A_wqkv": _A_in["wqkv"],
        "A_wo": _A_in["wo"],
        "B_x": _B_in["x"],
        "B_wqkv": _B_in["wqkv"],
        "B_wo": _B_in["wo"],
    }

def reference(A_x, A_wqkv, A_wo, B_x, B_wqkv, B_wo):
    def _A_ref(x, wqkv, wo):
        B, S, D = x.shape
        H = 32; Dh = D // H
        W, dil = 8, 2
        qkv = (lambda x, *d: x.permute(*d))((x @ wqkv).reshape(B, S, 3, H, Dh), 2, 0, 3, 1, 4)
        q, k, v = qkv[0], qkv[1], qkv[2]
        scale = Dh ** -0.5
        pos = torch.arange(S)
        off = torch.arange(W) * dil
        idx = pos[:, None] - off[None, :]
        mask = idx >= 0
        idx_c = torch.where(mask, idx, 0).reshape(-1)
        kg = k[:, :, idx_c, :].reshape(B, H, S, W, Dh)
        vg = v[:, :, idx_c, :].reshape(B, H, S, W, Dh)
        logits = torch.einsum("bhsd,bhswd->bhsw", q, kg) * scale
        logits = torch.where(mask[None, None, :, :], logits, -1e9)
        attn = _softmax(logits, axis=-1)
        o = torch.einsum("bhsw,bhswd->bhsd", attn, vg)
        return (lambda x, *d: x.permute(*d))(o, 0, 2, 1, 3).reshape(B, S, D) @ wo

    def _B_ref(x, wqkv, wo):
        B, S, D = x.shape
        H = 32; Dh = D // H
        qkv = (lambda x, *d: x.permute(*d))((x @ wqkv).reshape(B, S, 3, H, Dh), 2, 0, 3, 1, 4)
        q, k, v = qkv[0], qkv[1], qkv[2]
        phi = lambda t: torch.where(t > 0, t + 1, torch.exp(t)) + 1e-6
        pq, pk = phi(q), phi(k)
        kv = torch.einsum("bhsd,bhse->bhde", pk, v)
        z = torch.einsum("bhsd->bhd", pk)
        num = torch.einsum("bhqd,bhde->bhqe", pq, kv)
        den = torch.einsum("bhqd,bhd->bhq", pq, z)[..., None] + 1e-6
        o = num / den
        return (lambda x, *d: x.permute(*d))(o, 0, 2, 1, 3).reshape(B, S, D) @ wo

    a = _A_ref(A_x, A_wqkv, A_wo)
    b = _B_ref(B_x, B_wqkv, B_wo)
    return torch.concatenate([a, b], axis=-1)
```

```asm
; @launch grid=(256,1,1) block=(768,1,1) lds=159744
.amdgcn_target "amdgcn-amd-amdhsa--gfx950"
.text
.globl concat_heads__sliding_local_dilated__linear_attn_block__prompt_kernel
.p2align 8
.type concat_heads__sliding_local_dilated__linear_attn_block__prompt_kernel,@function
concat_heads__sliding_local_dilated__linear_attn_block__prompt_kernel:
  s_cmp_ge_u32 s2, 256
  s_cbranch_scc1 L_end
  s_load_dwordx16 s[4:19], s[0:1], 0
  s_load_dwordx2 s[20:21], s[0:1], 64
  v_lshrrev_b32 v1, 6, v0
  v_and_b32 v0, 63, v0
  v_readfirstlane_b32 s51, v1
  s_and_b32 s57, s2, 7
  s_lshr_b32 s52, s2, 3
  s_lshr_b32 s46, s57, 2
  s_xor_b32 s46, s46, 1
  s_and_b32 s53, s57, 3
  s_lshr_b32 s58, s53, 1
  s_lshl_b32 s58, s58, 3
  s_lshr_b32 s59, s52, 2
  s_add_u32 s47, s58, s59
  s_and_b32 s58, s53, 1
  s_lshl_b32 s58, s58, 2
  s_and_b32 s50, s52, 3
  s_add_u32 s48, s58, s50
  s_lshl_b32 s58, s53, 3
  s_add_u32 s49, s58, s59
  s_mov_b32 s73, 0
  s_cmp_lt_u32 s51, 8
  s_cbranch_scc1 L_comp
  s_sub_u32 s51, s51, 8
  v_lshrrev_b32 v11, 3, v0
  v_and_b32 v12, 7, v0
  v_lshrrev_b32 v13, 4, v0
  v_xor_b32 v14, v12, v13
  v_lshlrev_b32 v14, 4, v14
  v_lshl_add_u32 v1, v11, 11, v14
  v_xor_b32 v2, 64, v1
  v_and_b32 v13, 1, v13
  v_lshlrev_b32 v13, 1, v13
  v_xor_b32 v14, v12, v13
  v_lshlrev_b32 v14, 4, v14
  v_mul_u32_u24 v3, 3072, v11
  v_add_u32 v3, v3, v14
  s_and_b32 s57, s51, 1
  s_lshl_b32 s58, s57, 6
  v_xor_b32 v3, s58, v3
  v_xor_b32 v4, s58, v1
  s_lshl_b32 s54, s47, 17
  s_sub_u32 s55, s54, 16384
  s_max_i32 s55, s55, 0
  s_lshl_b32 s71, s57, 10
  s_add_u32 s55, s55, s71
  s_lshl_b32 s58, s51, 15
  s_add_u32 s54, s54, s58
  s_lshl_b32 s70, s51, 12
  s_add_u32 s70, s70, 2048
  s_lshl_b32 s56, s48, 7
  s_mul_i32 s58, s51, 24576
  s_add_u32 s56, s56, s58
  s_lshl_b32 s69, s51, 10
  s_add_u32 s69, s69, 73728
  s_add_u32 s58, s59, s50
  s_and_b32 s58, s58, 3
  s_mul_i32 s58, s58, 0x11111111
  s_xor_b32 s23, s58, 0x76532410
  s_waitcnt lgkmcnt(0)
  s_cmp_eq_u32 s46, 0
  s_cselect_b32 s24, s4, s10
  s_cselect_b32 s25, s5, s11
  s_cselect_b32 s28, s6, s12
  s_cselect_b32 s29, s7, s13
  s_mov_b32 s26, 0x200000
  s_mov_b32 s27, 0x20000
  s_mov_b32 s30, 0x180000
  s_mov_b32 s31, 0x20000
  s_lshr_b32 s57, s23, 0
  s_and_b32 s57, s57, 7
  s_mul_i32 s59, s57, 196608
  s_add_u32 s59, s59, s56
  s_add_u32 s58, s59, 0
  s_add_u32 m0, s69, 0
  s_waitcnt vmcnt(19)
  buffer_load_dwordx4 v3, s[28:31], s58 offen lds
  s_add_u32 s58, s59, 1024
  s_add_u32 m0, s69, 4096
  s_waitcnt vmcnt(19)
  buffer_load_dwordx4 v3, s[28:31], s58 offen lds
  s_add_u32 s58, s59, 2048
  s_add_u32 m0, s69, 8192
  s_waitcnt vmcnt(19)
  buffer_load_dwordx4 v3, s[28:31], s58 offen lds
  s_lshr_b32 s57, s23, 0
  s_and_b32 s57, s57, 7
  s_lshl_b32 s57, s57, 7
  s_add_u32 s60, s57, s54
  s_add_u32 s58, s60, 0
  s_add_u32 m0, s70, 0
  s_waitcnt vmcnt(19)
  buffer_load_dwordx4 v1, s[24:27], s58 offen lds
  s_add_u32 s58, s60, 16384
  s_add_u32 m0, s70, 1024
  s_waitcnt vmcnt(19)
  buffer_load_dwordx4 v2, s[24:27], s58 offen lds
  s_add_u32 s58, s60, 1024
  s_add_u32 m0, s70, 2048
  s_waitcnt vmcnt(19)
  buffer_load_dwordx4 v1, s[24:27], s58 offen lds
  s_add_u32 s58, s60, 17408
  s_add_u32 m0, s70, 3072
  s_waitcnt vmcnt(19)
  buffer_load_dwordx4 v2, s[24:27], s58 offen lds
  s_add_u32 s68, s57, s55
  s_add_u32 s58, s68, 0
  s_add_u32 m0, s71, 0
  s_waitcnt vmcnt(19)
  buffer_load_dwordx4 v4, s[24:27], s58 offen lds
  s_lshr_b32 s57, s23, 0
  s_and_b32 s57, s57, 7
  s_mul_i32 s59, s57, 196608
  s_add_u32 s59, s59, s56
  s_add_u32 s58, s59, 98304
  s_add_u32 m0, s69, 12288
  s_waitcnt vmcnt(19)
  buffer_load_dwordx4 v3, s[28:31], s58 offen lds
  s_add_u32 s58, s59, 99328
  s_add_u32 m0, s69, 16384
  s_waitcnt vmcnt(19)
  buffer_load_dwordx4 v3, s[28:31], s58 offen lds
  s_add_u32 s58, s59, 100352
  s_add_u32 m0, s69, 20480
  s_waitcnt vmcnt(19)
  buffer_load_dwordx4 v3, s[28:31], s58 offen lds
  s_lshr_b32 s57, s23, 4
  s_and_b32 s57, s57, 7
  s_lshl_b32 s57, s57, 7
  s_add_u32 s60, s57, s54
  s_add_u32 s58, s60, 0
  s_add_u32 m0, s70, 18432
  s_waitcnt vmcnt(19)
  buffer_load_dwordx4 v1, s[24:27], s58 offen lds
  s_add_u32 s58, s60, 16384
  s_add_u32 m0, s70, 19456
  s_waitcnt vmcnt(19)
  buffer_load_dwordx4 v2, s[24:27], s58 offen lds
  s_add_u32 s58, s60, 1024
  s_add_u32 m0, s70, 20480
  s_waitcnt vmcnt(19)
  buffer_load_dwordx4 v1, s[24:27], s58 offen lds
  s_cmp_eq_u32 s46, 0
  s_cselect_b32 s32, s8, s14
  s_cselect_b32 s33, s9, s15
  s_mov_b32 s34, 0x80000
  s_mov_b32 s35, 0x20000
  s_mov_b32 s36, s16
  s_mov_b32 s37, s17
  s_mov_b32 s38, 0x400000
  s_mov_b32 s39, 0x20000
  s_mov_b32 s40, s20
  s_mov_b32 s41, s21
  s_mov_b32 s42, 0x500000
  s_mov_b32 s43, 0x20000
  s_mov_b32 s44, s18
  s_mov_b32 s45, s19
  s_and_b32 s59, s51, 1
  s_cmp_eq_u32 s59, 0
  s_mov_b32 s12, 98304
  s_cselect_b32 s12, 2048, s12
  s_mov_b32 s13, 20480
  s_cselect_b32 s13, 114688, s13
  s_mov_b32 s14, 38912
  s_cselect_b32 s14, 131072, s14
  s_mov_b32 s15, 73728
  s_cselect_b32 s15, 57344, s15
  s_add_u32 s57, s50, 0
  s_and_b32 s57, s57, 3
  s_lshl_b32 s4, s57, 12
  s_add_u32 s57, s50, 1
  s_and_b32 s57, s57, 3
  s_lshl_b32 s5, s57, 12
  s_add_u32 s57, s50, 2
  s_and_b32 s57, s57, 3
  s_lshl_b32 s6, s57, 12
  s_add_u32 s57, s50, 3
  s_and_b32 s57, s57, 3
  s_lshl_b32 s7, s57, 12
  v_lshrrev_b32 v11, 3, v0
  v_and_b32 v12, 7, v0
  v_bfe_u32 v13, v0, 4, 1
  v_lshlrev_b32 v13, 2, v13
  v_xor_b32 v12, v12, v13
  v_lshlrev_b32 v12, 4, v12
  v_lshl_add_u32 v5, v11, 10, v12
  s_lshl_b32 s16, s50, 8
  s_lshl_b32 s57, s59, 7
  s_add_u32 s16, s16, s57
  s_lshr_b32 s57, s51, 1
  s_lshl_b32 s58, s57, 16
  s_add_u32 s16, s16, s58
  s_lshl_b32 s57, s57, 13
  s_add_u32 s12, s12, s57
  s_add_u32 s13, s13, s57
  s_add_u32 s14, s14, s57
  s_add_u32 s15, s15, s57
  s_lshl_b32 s22, s46, 7
  s_lshl_b32 s58, s47, 3
  s_add_u32 s22, s22, s58
  s_add_u32 s22, s22, s48
  s_lshl_b32 s22, s22, 7
  s_add_u32 s22, s22, 4259840
  v_mov_b32 v8, 1
  v_mov_b32 v15, 0
  v_and_b32 v10, 7, v0
  v_lshlrev_b32 v10, 2, v10
  v_lshlrev_b32 v6, 7, v0
  v_lshlrev_b32 v7, 4, v0
  s_waitcnt vmcnt(6)
  s_barrier
  s_lshr_b32 s57, s23, 4
  s_and_b32 s57, s57, 7
  s_lshl_b32 s57, s57, 7
  s_add_u32 s60, s57, s54
  s_add_u32 s58, s60, 17408
  s_add_u32 m0, s70, 21504
  s_waitcnt vmcnt(19)
  buffer_load_dwordx4 v2, s[24:27], s58 offen lds
  s_add_u32 s68, s57, s55
  s_add_u32 s58, s68, 0
  s_add_u32 m0, s71, 18432
  s_waitcnt vmcnt(19)
  buffer_load_dwordx4 v4, s[24:27], s58 offen lds
  s_lshr_b32 s57, s23, 4
  s_and_b32 s57, s57, 7
  s_mul_i32 s59, s57, 196608
  s_add_u32 s59, s59, s56
  s_add_u32 s58, s59, 0
  s_add_u32 m0, s69, 24576
  s_waitcnt vmcnt(19)
  buffer_load_dwordx4 v3, s[28:31], s58 offen lds
  s_add_u32 s58, s59, 1024
  s_add_u32 m0, s69, 28672
  s_waitcnt vmcnt(19)
  buffer_load_dwordx4 v3, s[28:31], s58 offen lds
  s_add_u32 s58, s59, 2048
  s_add_u32 m0, s69, 32768
  s_waitcnt vmcnt(19)
  buffer_load_dwordx4 v3, s[28:31], s58 offen lds
  s_waitcnt vmcnt(5)
  s_barrier
  s_lshr_b32 s57, s23, 4
  s_and_b32 s57, s57, 7
  s_mul_i32 s59, s57, 196608
  s_add_u32 s59, s59, s56
  s_add_u32 s58, s59, 98304
  s_add_u32 m0, s69, 36864
  s_waitcnt vmcnt(19)
  buffer_load_dwordx4 v3, s[28:31], s58 offen lds
  s_add_u32 s58, s59, 99328
  s_add_u32 m0, s69, 40960
  s_waitcnt vmcnt(19)
  buffer_load_dwordx4 v3, s[28:31], s58 offen lds
  s_add_u32 s58, s59, 100352
  s_add_u32 m0, s69, 45056
  s_waitcnt vmcnt(19)
  buffer_load_dwordx4 v3, s[28:31], s58 offen lds
  s_lshr_b32 s57, s23, 8
  s_and_b32 s57, s57, 7
  s_lshl_b32 s57, s57, 7
  s_add_u32 s60, s57, s54
  s_add_u32 s58, s60, 0
  s_add_u32 m0, s70, 36864
  s_waitcnt vmcnt(19)
  buffer_load_dwordx4 v1, s[24:27], s58 offen lds
  s_add_u32 s58, s60, 16384
  s_add_u32 m0, s70, 37888
  s_waitcnt vmcnt(19)
  buffer_load_dwordx4 v2, s[24:27], s58 offen lds
  s_add_u32 s58, s60, 1024
  s_add_u32 m0, s70, 38912
  s_waitcnt vmcnt(19)
  buffer_load_dwordx4 v1, s[24:27], s58 offen lds
  s_waitcnt vmcnt(6)
  s_barrier
  s_lshr_b32 s57, s23, 8
  s_and_b32 s57, s57, 7
  s_lshl_b32 s57, s57, 7
  s_add_u32 s60, s57, s54
  s_add_u32 s58, s60, 17408
  s_add_u32 m0, s70, 39936
  s_waitcnt vmcnt(19)
  buffer_load_dwordx4 v2, s[24:27], s58 offen lds
  s_add_u32 s68, s57, s55
  s_add_u32 s58, s68, 0
  s_add_u32 m0, s71, 36864
  s_waitcnt vmcnt(19)
  buffer_load_dwordx4 v4, s[24:27], s58 offen lds
  s_lshr_b32 s57, s23, 8
  s_and_b32 s57, s57, 7
  s_mul_i32 s59, s57, 196608
  s_add_u32 s59, s59, s56
  s_add_u32 s58, s59, 0
  s_add_u32 m0, s69, 49152
  s_waitcnt vmcnt(19)
  buffer_load_dwordx4 v3, s[28:31], s58 offen lds
  s_add_u32 s58, s59, 1024
  s_add_u32 m0, s69, 53248
  s_waitcnt vmcnt(19)
  buffer_load_dwordx4 v3, s[28:31], s58 offen lds
  s_add_u32 s58, s59, 2048
  s_add_u32 m0, s69, 57344
  s_waitcnt vmcnt(19)
  buffer_load_dwordx4 v3, s[28:31], s58 offen lds
  s_lshr_b32 s57, s23, 8
  s_and_b32 s57, s57, 7
  s_mul_i32 s59, s57, 196608
  s_add_u32 s59, s59, s56
  s_add_u32 s58, s59, 98304
  s_add_u32 m0, s69, 61440
  s_waitcnt vmcnt(19)
  buffer_load_dwordx4 v3, s[28:31], s58 offen lds
  s_add_u32 s58, s59, 99328
  s_add_u32 m0, s69, 65536
  s_waitcnt vmcnt(19)
  buffer_load_dwordx4 v3, s[28:31], s58 offen lds
  s_add_u32 s58, s59, 100352
  s_add_u32 m0, s69, 69632
  s_waitcnt vmcnt(19)
  buffer_load_dwordx4 v3, s[28:31], s58 offen lds
  s_lshr_b32 s57, s23, 12
  s_and_b32 s57, s57, 7
  s_lshl_b32 s57, s57, 7
  s_add_u32 s60, s57, s54
  s_add_u32 s58, s60, 0
  s_add_u32 m0, s70, 55296
  s_waitcnt vmcnt(19)
  buffer_load_dwordx4 v1, s[24:27], s58 offen lds
  s_add_u32 s58, s60, 16384
  s_add_u32 m0, s70, 56320
  s_waitcnt vmcnt(19)
  buffer_load_dwordx4 v2, s[24:27], s58 offen lds
  s_add_u32 s58, s60, 1024
  s_add_u32 m0, s70, 57344
  s_waitcnt vmcnt(19)
  buffer_load_dwordx4 v1, s[24:27], s58 offen lds
  s_lshr_b32 s57, s23, 12
  s_and_b32 s57, s57, 7
  s_lshl_b32 s57, s57, 7
  s_add_u32 s60, s57, s54
  s_add_u32 s58, s60, 17408
  s_add_u32 m0, s70, 58368
  s_waitcnt vmcnt(19)
  buffer_load_dwordx4 v2, s[24:27], s58 offen lds
  s_add_u32 s68, s57, s55
  s_add_u32 s58, s68, 0
  s_add_u32 m0, s71, 55296
  s_waitcnt vmcnt(19)
  buffer_load_dwordx4 v4, s[24:27], s58 offen lds
  s_lshr_b32 s57, s23, 12
  s_and_b32 s57, s57, 7
  s_mul_i32 s59, s57, 196608
  s_add_u32 s59, s59, s56
  s_add_u32 s58, s59, 0
  s_add_u32 m0, s69, 73728
  s_waitcnt vmcnt(19)
  buffer_load_dwordx4 v3, s[28:31], s58 offen lds
  s_add_u32 s58, s59, 1024
  s_add_u32 m0, s69, 77824
  s_waitcnt vmcnt(19)
  buffer_load_dwordx4 v3, s[28:31], s58 offen lds
  s_add_u32 s58, s59, 2048
  s_add_u32 m0, s69, 81920
  s_waitcnt vmcnt(19)
  buffer_load_dwordx4 v3, s[28:31], s58 offen lds
  s_waitcnt vmcnt(16)
  s_barrier
  s_lshr_b32 s57, s23, 12
  s_and_b32 s57, s57, 7
  s_mul_i32 s59, s57, 196608
  s_add_u32 s59, s59, s56
  s_add_u32 s58, s59, 98304
  s_add_u32 m0, s69, 0
  s_waitcnt vmcnt(19)
  buffer_load_dwordx4 v3, s[28:31], s58 offen lds
  s_add_u32 s58, s59, 99328
  s_add_u32 m0, s69, 4096
  s_waitcnt vmcnt(19)
  buffer_load_dwordx4 v3, s[28:31], s58 offen lds
  s_add_u32 s58, s59, 100352
  s_add_u32 m0, s69, 8192
  s_waitcnt vmcnt(19)
  buffer_load_dwordx4 v3, s[28:31], s58 offen lds
  s_lshr_b32 s57, s23, 16
  s_and_b32 s57, s57, 7
  s_lshl_b32 s57, s57, 7
  s_add_u32 s60, s57, s54
  s_add_u32 s58, s60, 0
  s_add_u32 m0, s70, 0
  s_waitcnt vmcnt(19)
  buffer_load_dwordx4 v1, s[24:27], s58 offen lds
  s_add_u32 s58, s60, 16384
  s_add_u32 m0, s70, 1024
  s_waitcnt vmcnt(19)
  buffer_load_dwordx4 v2, s[24:27], s58 offen lds
  s_add_u32 s58, s60, 1024
  s_add_u32 m0, s70, 2048
  s_waitcnt vmcnt(19)
  buffer_load_dwordx4 v1, s[24:27], s58 offen lds
  s_waitcnt vmcnt(17)
  s_barrier
  s_lshr_b32 s57, s23, 16
  s_and_b32 s57, s57, 7
  s_lshl_b32 s57, s57, 7
  s_add_u32 s60, s57, s54
  s_add_u32 s58, s60, 17408
  s_add_u32 m0, s70, 3072
  s_waitcnt vmcnt(19)
  buffer_load_dwordx4 v2, s[24:27], s58 offen lds
  s_add_u32 s68, s57, s55
  s_add_u32 s58, s68, 0
  s_add_u32 m0, s71, 0
  s_waitcnt vmcnt(19)
  buffer_load_dwordx4 v4, s[24:27], s58 offen lds
  s_lshr_b32 s57, s23, 16
  s_and_b32 s57, s57, 7
  s_mul_i32 s59, s57, 196608
  s_add_u32 s59, s59, s56
  s_add_u32 s58, s59, 0
  s_add_u32 m0, s69, 12288
  s_waitcnt vmcnt(19)
  buffer_load_dwordx4 v3, s[28:31], s58 offen lds
  s_add_u32 s58, s59, 1024
  s_add_u32 m0, s69, 16384
  s_waitcnt vmcnt(19)
  buffer_load_dwordx4 v3, s[28:31], s58 offen lds
  s_add_u32 s58, s59, 2048
  s_add_u32 m0, s69, 20480
  s_waitcnt vmcnt(19)
  buffer_load_dwordx4 v3, s[28:31], s58 offen lds
  s_waitcnt vmcnt(16)
  s_barrier
  s_lshr_b32 s57, s23, 16
  s_and_b32 s57, s57, 7
  s_mul_i32 s59, s57, 196608
  s_add_u32 s59, s59, s56
  s_add_u32 s58, s59, 98304
  s_add_u32 m0, s69, 24576
  s_waitcnt vmcnt(19)
  buffer_load_dwordx4 v3, s[28:31], s58 offen lds
  s_add_u32 s58, s59, 99328
  s_add_u32 m0, s69, 28672
  s_waitcnt vmcnt(19)
  buffer_load_dwordx4 v3, s[28:31], s58 offen lds
  s_add_u32 s58, s59, 100352
  s_add_u32 m0, s69, 32768
  s_waitcnt vmcnt(19)
  buffer_load_dwordx4 v3, s[28:31], s58 offen lds
  s_lshr_b32 s57, s23, 20
  s_and_b32 s57, s57, 7
  s_lshl_b32 s57, s57, 7
  s_add_u32 s60, s57, s54
  s_add_u32 s58, s60, 0
  s_add_u32 m0, s70, 18432
  s_waitcnt vmcnt(19)
  buffer_load_dwordx4 v1, s[24:27], s58 offen lds
  s_add_u32 s58, s60, 16384
  s_add_u32 m0, s70, 19456
  s_waitcnt vmcnt(19)
  buffer_load_dwordx4 v2, s[24:27], s58 offen lds
  s_add_u32 s58, s60, 1024
  s_add_u32 m0, s70, 20480
  s_waitcnt vmcnt(19)
  buffer_load_dwordx4 v1, s[24:27], s58 offen lds
  v_lshlrev_b32 v9, 7, v0
  s_lshl_b32 s58, s52, 14
  s_lshl_b32 s57, s51, 12
  s_add_u32 s58, s58, s57
  s_mov_b32 exec_hi, 0
  buffer_load_dword v11, v9, s[32:35], s58 offen
  s_mov_b64 exec, -1
  s_waitcnt vmcnt(18)
  s_barrier
  s_lshr_b32 s57, s23, 20
  s_and_b32 s57, s57, 7
  s_lshl_b32 s57, s57, 7
  s_add_u32 s60, s57, s54
  s_add_u32 s58, s60, 17408
  s_add_u32 m0, s70, 21504
  s_waitcnt vmcnt(19)
  buffer_load_dwordx4 v2, s[24:27], s58 offen lds
  s_add_u32 s68, s57, s55
  s_add_u32 s58, s68, 0
  s_add_u32 m0, s71, 18432
  s_waitcnt vmcnt(19)
  buffer_load_dwordx4 v4, s[24:27], s58 offen lds
  s_lshr_b32 s57, s23, 20
  s_and_b32 s57, s57, 7
  s_mul_i32 s59, s57, 196608
  s_add_u32 s59, s59, s56
  s_add_u32 s58, s59, 0
  s_add_u32 m0, s69, 36864
  s_waitcnt vmcnt(19)
  buffer_load_dwordx4 v3, s[28:31], s58 offen lds
  s_add_u32 s58, s59, 1024
  s_add_u32 m0, s69, 40960
  s_waitcnt vmcnt(19)
  buffer_load_dwordx4 v3, s[28:31], s58 offen lds
  s_add_u32 s58, s59, 2048
  s_add_u32 m0, s69, 45056
  s_waitcnt vmcnt(19)
  buffer_load_dwordx4 v3, s[28:31], s58 offen lds
  s_waitcnt vmcnt(17)
  s_barrier
  s_lshr_b32 s57, s23, 20
  s_and_b32 s57, s57, 7
  s_mul_i32 s59, s57, 196608
  s_add_u32 s59, s59, s56
  s_add_u32 s58, s59, 98304
  s_add_u32 m0, s69, 49152
  s_waitcnt vmcnt(19)
  buffer_load_dwordx4 v3, s[28:31], s58 offen lds
  s_add_u32 s58, s59, 99328
  s_add_u32 m0, s69, 53248
  s_waitcnt vmcnt(19)
  buffer_load_dwordx4 v3, s[28:31], s58 offen lds
  s_add_u32 s58, s59, 100352
  s_add_u32 m0, s69, 57344
  s_waitcnt vmcnt(19)
  buffer_load_dwordx4 v3, s[28:31], s58 offen lds
  s_lshr_b32 s57, s23, 24
  s_and_b32 s57, s57, 7
  s_lshl_b32 s57, s57, 7
  s_add_u32 s60, s57, s54
  s_add_u32 s58, s60, 0
  s_add_u32 m0, s70, 36864
  s_waitcnt vmcnt(19)
  buffer_load_dwordx4 v1, s[24:27], s58 offen lds
  s_add_u32 s58, s60, 16384
  s_add_u32 m0, s70, 37888
  s_waitcnt vmcnt(19)
  buffer_load_dwordx4 v2, s[24:27], s58 offen lds
  s_add_u32 s58, s60, 1024
  s_add_u32 m0, s70, 38912
  s_waitcnt vmcnt(19)
  buffer_load_dwordx4 v1, s[24:27], s58 offen lds
  s_waitcnt vmcnt(18)
  s_barrier
  s_lshr_b32 s57, s23, 24
  s_and_b32 s57, s57, 7
  s_lshl_b32 s57, s57, 7
  s_add_u32 s60, s57, s54
  s_add_u32 s58, s60, 17408
  s_add_u32 m0, s70, 39936
  s_waitcnt vmcnt(19)
  buffer_load_dwordx4 v2, s[24:27], s58 offen lds
  s_add_u32 s68, s57, s55
  s_add_u32 s58, s68, 0
  s_add_u32 m0, s71, 36864
  s_waitcnt vmcnt(19)
  buffer_load_dwordx4 v4, s[24:27], s58 offen lds
  s_lshr_b32 s57, s23, 24
  s_and_b32 s57, s57, 7
  s_mul_i32 s59, s57, 196608
  s_add_u32 s59, s59, s56
  s_add_u32 s58, s59, 0
  s_add_u32 m0, s69, 61440
  s_waitcnt vmcnt(19)
  buffer_load_dwordx4 v3, s[28:31], s58 offen lds
  s_add_u32 s58, s59, 1024
  s_add_u32 m0, s69, 65536
  s_waitcnt vmcnt(19)
  buffer_load_dwordx4 v3, s[28:31], s58 offen lds
  s_add_u32 s58, s59, 2048
  s_add_u32 m0, s69, 69632
  s_waitcnt vmcnt(19)
  buffer_load_dwordx4 v3, s[28:31], s58 offen lds
  s_waitcnt vmcnt(17)
  s_barrier
  s_lshr_b32 s57, s23, 24
  s_and_b32 s57, s57, 7
  s_mul_i32 s59, s57, 196608
  s_add_u32 s59, s59, s56
  s_add_u32 s58, s59, 98304
  s_add_u32 m0, s69, 73728
  s_waitcnt vmcnt(19)
  buffer_load_dwordx4 v3, s[28:31], s58 offen lds
  s_add_u32 s58, s59, 99328
  s_add_u32 m0, s69, 77824
  s_waitcnt vmcnt(19)
  buffer_load_dwordx4 v3, s[28:31], s58 offen lds
  s_add_u32 s58, s59, 100352
  s_add_u32 m0, s69, 81920
  s_waitcnt vmcnt(19)
  buffer_load_dwordx4 v3, s[28:31], s58 offen lds
  s_lshr_b32 s57, s23, 28
  s_and_b32 s57, s57, 7
  s_lshl_b32 s57, s57, 7
  s_add_u32 s60, s57, s54
  s_add_u32 s58, s60, 0
  s_add_u32 m0, s70, 55296
  s_waitcnt vmcnt(19)
  buffer_load_dwordx4 v1, s[24:27], s58 offen lds
  s_add_u32 s58, s60, 16384
  s_add_u32 m0, s70, 56320
  s_waitcnt vmcnt(19)
  buffer_load_dwordx4 v2, s[24:27], s58 offen lds
  s_add_u32 s58, s60, 1024
  s_add_u32 m0, s70, 57344
  s_waitcnt vmcnt(19)
  buffer_load_dwordx4 v1, s[24:27], s58 offen lds
  s_waitcnt vmcnt(17)
  s_barrier
  s_lshr_b32 s57, s23, 28
  s_and_b32 s57, s57, 7
  s_lshl_b32 s57, s57, 7
  s_add_u32 s60, s57, s54
  s_add_u32 s58, s60, 17408
  s_add_u32 m0, s70, 58368
  s_waitcnt vmcnt(19)
  buffer_load_dwordx4 v2, s[24:27], s58 offen lds
  s_add_u32 s68, s57, s55
  s_add_u32 s58, s68, 0
  s_add_u32 m0, s71, 55296
  s_waitcnt vmcnt(19)
  buffer_load_dwordx4 v4, s[24:27], s58 offen lds
  s_lshr_b32 s57, s23, 28
  s_and_b32 s57, s57, 7
  s_mul_i32 s59, s57, 196608
  s_add_u32 s59, s59, s56
  s_add_u32 s58, s59, 0
  s_add_u32 m0, s69, 0
  s_waitcnt vmcnt(19)
  buffer_load_dwordx4 v3, s[28:31], s58 offen lds
  s_add_u32 s58, s59, 1024
  s_add_u32 m0, s69, 4096
  s_waitcnt vmcnt(19)
  buffer_load_dwordx4 v3, s[28:31], s58 offen lds
  s_add_u32 s58, s59, 2048
  s_add_u32 m0, s69, 8192
  s_waitcnt vmcnt(19)
  buffer_load_dwordx4 v3, s[28:31], s58 offen lds
  s_waitcnt vmcnt(16)
  s_barrier
  s_lshr_b32 s57, s23, 28
  s_and_b32 s57, s57, 7
  s_mul_i32 s59, s57, 196608
  s_add_u32 s59, s59, s56
  s_add_u32 s58, s59, 98304
  s_add_u32 m0, s69, 12288
  s_waitcnt vmcnt(19)
  buffer_load_dwordx4 v3, s[28:31], s58 offen lds
  s_add_u32 s58, s59, 99328
  s_add_u32 m0, s69, 16384
  s_waitcnt vmcnt(19)
  buffer_load_dwordx4 v3, s[28:31], s58 offen lds
  s_add_u32 s58, s59, 100352
  s_add_u32 m0, s69, 20480
  s_waitcnt vmcnt(19)
  buffer_load_dwordx4 v3, s[28:31], s58 offen lds
  s_lshl_b32 s57, s4, 5
  s_add_u32 s59, s57, s16
  s_add_u32 s58, s59, 0
  s_add_u32 m0, s12, 0
  s_waitcnt vmcnt(19)
  buffer_load_dwordx4 v5, s[32:35], s58 offen lds
  s_add_u32 s58, s59, 8192
  s_add_u32 m0, s12, 1024
  s_waitcnt vmcnt(19)
  buffer_load_dwordx4 v5, s[32:35], s58 offen lds
  s_add_u32 s58, s59, 16384
  s_add_u32 m0, s12, 2048
  s_waitcnt vmcnt(19)
  buffer_load_dwordx4 v5, s[32:35], s58 offen lds
  s_add_u32 s58, s59, 24576
  s_add_u32 m0, s12, 3072
  s_waitcnt vmcnt(19)
  buffer_load_dwordx4 v5, s[32:35], s58 offen lds
  s_add_u32 s58, s59, 32768
  s_add_u32 m0, s12, 4096
  s_waitcnt vmcnt(19)
  buffer_load_dwordx4 v5, s[32:35], s58 offen lds
  s_add_u32 s58, s59, 40960
  s_add_u32 m0, s12, 5120
  s_waitcnt vmcnt(19)
  buffer_load_dwordx4 v5, s[32:35], s58 offen lds
  s_add_u32 s58, s59, 49152
  s_add_u32 m0, s12, 6144
  s_waitcnt vmcnt(19)
  buffer_load_dwordx4 v5, s[32:35], s58 offen lds
  s_add_u32 s58, s59, 57344
  s_add_u32 m0, s12, 7168
  s_waitcnt vmcnt(19)
  buffer_load_dwordx4 v5, s[32:35], s58 offen lds
  s_waitcnt vmcnt(22)
  s_barrier
  s_lshl_b32 s57, s5, 5
  s_add_u32 s59, s57, s16
  s_add_u32 s58, s59, 0
  s_add_u32 m0, s13, 0
  s_waitcnt vmcnt(19)
  buffer_load_dwordx4 v5, s[32:35], s58 offen lds
  s_add_u32 s58, s59, 8192
  s_add_u32 m0, s13, 1024
  s_waitcnt vmcnt(19)
  buffer_load_dwordx4 v5, s[32:35], s58 offen lds
  s_add_u32 s58, s59, 16384
  s_add_u32 m0, s13, 2048
  s_waitcnt vmcnt(19)
  buffer_load_dwordx4 v5, s[32:35], s58 offen lds
  s_add_u32 s58, s59, 24576
  s_add_u32 m0, s13, 3072
  s_waitcnt vmcnt(19)
  buffer_load_dwordx4 v5, s[32:35], s58 offen lds
  s_add_u32 s58, s59, 32768
  s_add_u32 m0, s13, 4096
  s_waitcnt vmcnt(19)
  buffer_load_dwordx4 v5, s[32:35], s58 offen lds
  s_add_u32 s58, s59, 40960
  s_add_u32 m0, s13, 5120
  s_waitcnt vmcnt(19)
  buffer_load_dwordx4 v5, s[32:35], s58 offen lds
  s_add_u32 s58, s59, 49152
  s_add_u32 m0, s13, 6144
  s_waitcnt vmcnt(19)
  buffer_load_dwordx4 v5, s[32:35], s58 offen lds
  s_add_u32 s58, s59, 57344
  s_add_u32 m0, s13, 7168
  s_waitcnt vmcnt(19)
  buffer_load_dwordx4 v5, s[32:35], s58 offen lds
  s_waitcnt vmcnt(24)
  s_barrier
  s_waitcnt vmcnt(19)
  s_barrier
  s_lshl_b32 s57, s6, 5
  s_add_u32 s59, s57, s16
  s_add_u32 s58, s59, 0
  s_add_u32 m0, s14, 0
  s_waitcnt vmcnt(19)
  buffer_load_dwordx4 v5, s[32:35], s58 offen lds
  s_add_u32 s58, s59, 8192
  s_add_u32 m0, s14, 1024
  s_waitcnt vmcnt(19)
  buffer_load_dwordx4 v5, s[32:35], s58 offen lds
  s_add_u32 s58, s59, 16384
  s_add_u32 m0, s14, 2048
  s_waitcnt vmcnt(19)
  buffer_load_dwordx4 v5, s[32:35], s58 offen lds
  s_add_u32 s58, s59, 24576
  s_add_u32 m0, s14, 3072
  s_waitcnt vmcnt(19)
  buffer_load_dwordx4 v5, s[32:35], s58 offen lds
  s_add_u32 s58, s59, 32768
  s_add_u32 m0, s14, 4096
  s_waitcnt vmcnt(19)
  buffer_load_dwordx4 v5, s[32:35], s58 offen lds
  s_add_u32 s58, s59, 40960
  s_add_u32 m0, s14, 5120
  s_waitcnt vmcnt(19)
  buffer_load_dwordx4 v5, s[32:35], s58 offen lds
  s_add_u32 s58, s59, 49152
  s_add_u32 m0, s14, 6144
  s_waitcnt vmcnt(19)
  buffer_load_dwordx4 v5, s[32:35], s58 offen lds
  s_add_u32 s58, s59, 57344
  s_add_u32 m0, s14, 7168
  s_waitcnt vmcnt(19)
  buffer_load_dwordx4 v5, s[32:35], s58 offen lds
  s_waitcnt vmcnt(24)
  s_barrier
  s_barrier
  s_lshl_b32 s57, s7, 5
  s_add_u32 s59, s57, s16
  s_add_u32 s58, s59, 0
  s_add_u32 m0, s15, 0
  s_waitcnt vmcnt(19)
  buffer_load_dwordx4 v5, s[32:35], s58 offen lds
  s_add_u32 s58, s59, 8192
  s_add_u32 m0, s15, 1024
  s_waitcnt vmcnt(19)
  buffer_load_dwordx4 v5, s[32:35], s58 offen lds
  s_add_u32 s58, s59, 16384
  s_add_u32 m0, s15, 2048
  s_waitcnt vmcnt(19)
  buffer_load_dwordx4 v5, s[32:35], s58 offen lds
  s_add_u32 s58, s59, 24576
  s_add_u32 m0, s15, 3072
  s_waitcnt vmcnt(19)
  buffer_load_dwordx4 v5, s[32:35], s58 offen lds
  s_add_u32 s58, s59, 32768
  s_add_u32 m0, s15, 4096
  s_waitcnt vmcnt(19)
  buffer_load_dwordx4 v5, s[32:35], s58 offen lds
  s_add_u32 s58, s59, 40960
  s_add_u32 m0, s15, 5120
  s_waitcnt vmcnt(19)
  buffer_load_dwordx4 v5, s[32:35], s58 offen lds
  s_add_u32 s58, s59, 49152
  s_add_u32 m0, s15, 6144
  s_waitcnt vmcnt(19)
  buffer_load_dwordx4 v5, s[32:35], s58 offen lds
  s_add_u32 s58, s59, 57344
  s_add_u32 m0, s15, 7168
  s_waitcnt vmcnt(19)
  buffer_load_dwordx4 v5, s[32:35], s58 offen lds
  s_barrier
  s_cmp_lg_u32 s51, 0
  s_cbranch_scc1 L_nofl
  s_mov_b64 exec, 1
  buffer_store_dword v8, v15, s[40:43], s22 offen sc1
  s_mov_b64 exec, -1
  s_waitcnt vmcnt(17)
  s_branch L_fl2
L_nofl:
  s_waitcnt vmcnt(16)
L_fl2:
  s_barrier
  v_lshrrev_b32 v11, 2, v0
  v_lshlrev_b32 v11, 4, v11
  v_bfe_u32 v12, v0, 1, 1
  v_lshl_add_u32 v11, v12, 8, v11
  v_and_b32 v12, 1, v0
  v_lshl_add_u32 v11, v12, 3, v11
  s_lshl_b32 s16, s51, 3
  s_mul_i32 s17, s16, 1152
  s_add_u32 s17, s17, 4194304
  v_bfe_u32 v12, v0, 2, 3
  v_mul_u32_u24 v13, 1152, v12
  v_and_b32 v14, 3, v0
  v_lshl_add_u32 v13, v14, 4, v13
  v_add_u32 v13, 1024, v13
  v_add_u32 v12, s16, v12
  v_mul_u32_u24 v20, 544, v12
  v_lshl_add_u32 v20, v14, 3, v20
  v_add_u32 v20, 33280, v20
  v_add_u32 v21, 108704, v20
  v_cmp_lt_u32 vcc, 10, v12
  s_nop 1
  v_cndmask_b32 v20, v20, v21, vcc
  s_lshl_b32 s18, s51, 10
  s_add_u32 s18, s18, 4292608
  s_add_u32 s57, s52, 0
  s_and_b32 s57, s57, 7
  s_add_u32 s57, s57, 0
  s_mul_i32 s78, s57, 1152
  s_add_u32 s78, s78, s17
  s_add_u32 s57, s57, s16
  s_mul_i32 s58, s57, 544
  s_cmp_lt_u32 s57, 11
  s_cselect_b32 s57, 0, 108704
  s_add_u32 s58, s58, s57
  s_add_u32 s58, s58, 32768
  v_add_u32 v60, s58, v11
  s_add_u32 s57, s52, 1
  s_and_b32 s57, s57, 7
  s_add_u32 s57, s57, 0
  s_mul_i32 s79, s57, 1152
  s_add_u32 s79, s79, s17
  s_add_u32 s57, s57, s16
  s_mul_i32 s58, s57, 544
  s_cmp_lt_u32 s57, 11
  s_cselect_b32 s57, 0, 108704
  s_add_u32 s58, s58, s57
  s_add_u32 s58, s58, 32768
  v_add_u32 v61, s58, v11
  s_add_u32 s57, s52, 2
  s_and_b32 s57, s57, 7
  s_add_u32 s57, s57, 0
  s_mul_i32 s80, s57, 1152
  s_add_u32 s80, s80, s17
  s_add_u32 s57, s57, s16
  s_mul_i32 s58, s57, 544
  s_cmp_lt_u32 s57, 11
  s_cselect_b32 s57, 0, 108704
  s_add_u32 s58, s58, s57
  s_add_u32 s58, s58, 32768
  v_add_u32 v62, s58, v11
  s_add_u32 s57, s52, 3
  s_and_b32 s57, s57, 7
  s_add_u32 s57, s57, 0
  s_mul_i32 s81, s57, 1152
  s_add_u32 s81, s81, s17
  s_add_u32 s57, s57, s16
  s_mul_i32 s58, s57, 544
  s_cmp_lt_u32 s57, 11
  s_cselect_b32 s57, 0, 108704
  s_add_u32 s58, s58, s57
  s_add_u32 s58, s58, 32768
  v_add_u32 v63, s58, v11
  s_add_u32 s57, s52, 4
  s_and_b32 s57, s57, 7
  s_add_u32 s57, s57, 0
  s_mul_i32 s82, s57, 1152
  s_add_u32 s82, s82, s17
  s_add_u32 s57, s57, s16
  s_mul_i32 s58, s57, 544
  s_cmp_lt_u32 s57, 11
  s_cselect_b32 s57, 0, 108704
  s_add_u32 s58, s58, s57
  s_add_u32 s58, s58, 32768
  v_add_u32 v64, s58, v11
  s_add_u32 s57, s52, 5
  s_and_b32 s57, s57, 7
  s_add_u32 s57, s57, 0
  s_mul_i32 s83, s57, 1152
  s_add_u32 s83, s83, s17
  s_add_u32 s57, s57, s16
  s_mul_i32 s58, s57, 544
  s_cmp_lt_u32 s57, 11
  s_cselect_b32 s57, 0, 108704
  s_add_u32 s58, s58, s57
  s_add_u32 s58, s58, 32768
  v_add_u32 v65, s58, v11
  s_add_u32 s57, s52, 6
  s_and_b32 s57, s57, 7
  s_add_u32 s57, s57, 0
  s_mul_i32 s84, s57, 1152
  s_add_u32 s84, s84, s17
  s_add_u32 s57, s57, s16
  s_mul_i32 s58, s57, 544
  s_cmp_lt_u32 s57, 11
  s_cselect_b32 s57, 0, 108704
  s_add_u32 s58, s58, s57
  s_add_u32 s58, s58, 32768
  v_add_u32 v66, s58, v11
  s_add_u32 s57, s52, 7
  s_and_b32 s57, s57, 7
  s_add_u32 s57, s57, 0
  s_mul_i32 s85, s57, 1152
  s_add_u32 s85, s85, s17
  s_add_u32 s57, s57, s16
  s_mul_i32 s58, s57, 544
  s_cmp_lt_u32 s57, 11
  s_cselect_b32 s57, 0, 108704
  s_add_u32 s58, s58, s57
  s_add_u32 s58, s58, 32768
  v_add_u32 v67, s58, v11
  s_cmp_lg_u32 s51, 0
  s_cbranch_scc1 L_await
  s_lshr_b32 s58, s49, 1
  s_lshl_b32 s58, s58, 10
  s_lshl_b32 s57, s46, 14
  s_add_u32 s58, s58, s57
  s_add_u32 s58, s58, 4259840
  s_mov_b64 exec, 0xff
L_plR:
  buffer_load_dword v16, v6, s[40:43], s58 offen sc1
  s_waitcnt vmcnt(0)
  v_cmp_ne_u32 vcc, 1, v16
  s_and_b64 exec, exec, vcc
  s_cbranch_execz L_poR
  s_add_u32 s73, s73, 1
  s_cmp_gt_u32 s73, 0x40000
  s_cbranch_scc1 L_poR
  s_sleep 2
  s_branch L_plR
L_poR:
  s_mov_b64 exec, -1
L_await:
  s_lshl_b32 s60, s49, 16
  s_lshl_b32 s57, s51, 14
  s_add_u32 s60, s60, s57
  s_and_b32 s59, s51, 1
  s_lshl_b32 s59, s59, 14
  s_lshr_b32 s57, s51, 1
  s_mul_i32 s57, s57, 98304
  s_add_u32 s59, s59, s57
  s_waitcnt vmcnt(0)
  s_barrier
  s_cmp_eq_u32 s46, 0
  s_cbranch_scc1 L_oload
  s_mov_b64 exec, 0xff
L_plK:
  buffer_load_dword v16, v6, s[40:43], s18 offen sc1
  s_waitcnt vmcnt(0)
  v_cmp_ne_u32 vcc, 16, v16
  s_and_b64 exec, exec, vcc
  s_cbranch_execz L_poK
  s_add_u32 s73, s73, 1
  s_cmp_gt_u32 s73, 0x40000
  s_cbranch_scc1 L_poK
  s_sleep 10
  s_branch L_plK
L_poK:
  s_mov_b64 exec, -1
  buffer_load_dwordx4 v[24:27], v7, s[40:43], s78 offen
  buffer_load_dwordx4 v[28:31], v7, s[40:43], s79 offen
  buffer_load_dwordx4 v[32:35], v7, s[40:43], s80 offen
  buffer_load_dwordx4 v[36:39], v7, s[40:43], s81 offen
  buffer_load_dwordx4 v[40:43], v7, s[40:43], s82 offen
  buffer_load_dwordx4 v[44:47], v7, s[40:43], s83 offen
  buffer_load_dwordx4 v[48:51], v7, s[40:43], s84 offen
  buffer_load_dwordx4 v[52:55], v7, s[40:43], s85 offen
  buffer_load_dwordx4 v[56:59], v13, s[40:43], s17 offen
  s_barrier
  s_waitcnt vmcnt(8)
  v_cvt_pk_bf16_f32 v24, v24, v25
  v_cvt_pk_bf16_f32 v25, v26, v27
  ds_write_b64 v60, v[24:25]
  s_waitcnt vmcnt(7)
  v_cvt_pk_bf16_f32 v28, v28, v29
  v_cvt_pk_bf16_f32 v29, v30, v31
  ds_write_b64 v61, v[28:29]
  s_waitcnt vmcnt(6)
  v_cvt_pk_bf16_f32 v32, v32, v33
  v_cvt_pk_bf16_f32 v33, v34, v35
  ds_write_b64 v62, v[32:33]
  s_waitcnt vmcnt(5)
  v_cvt_pk_bf16_f32 v36, v36, v37
  v_cvt_pk_bf16_f32 v37, v38, v39
  ds_write_b64 v63, v[36:37]
  s_waitcnt vmcnt(4)
  v_cvt_pk_bf16_f32 v40, v40, v41
  v_cvt_pk_bf16_f32 v41, v42, v43
  ds_write_b64 v64, v[40:41]
  s_waitcnt vmcnt(3)
  v_cvt_pk_bf16_f32 v44, v44, v45
  v_cvt_pk_bf16_f32 v45, v46, v47
  ds_write_b64 v65, v[44:45]
  s_waitcnt vmcnt(2)
  v_cvt_pk_bf16_f32 v48, v48, v49
  v_cvt_pk_bf16_f32 v49, v50, v51
  ds_write_b64 v66, v[48:49]
  s_waitcnt vmcnt(1)
  v_cvt_pk_bf16_f32 v52, v52, v53
  v_cvt_pk_bf16_f32 v53, v54, v55
  ds_write_b64 v67, v[52:53]
  s_waitcnt vmcnt(0)
  v_cvt_pk_bf16_f32 v56, v56, v57
  v_cvt_pk_bf16_f32 v57, v58, v59
  ds_write_b64 v20, v[56:57]
  s_waitcnt lgkmcnt(0)
  s_barrier
  s_endpgm
L_oload:
  s_add_u32 s16, s60, s4
  s_add_u32 s17, s59, s4
  s_add_u32 s58, s16, 0
  s_add_u32 m0, s17, 0
  s_nop 0
  buffer_load_dwordx4 v7, s[40:43], s58 offen  lds
  s_add_u32 s58, s16, 1024
  s_add_u32 m0, s17, 1024
  s_nop 0
  buffer_load_dwordx4 v7, s[40:43], s58 offen  lds
  s_add_u32 s58, s16, 2048
  s_add_u32 m0, s17, 2048
  s_nop 0
  buffer_load_dwordx4 v7, s[40:43], s58 offen  lds
  s_add_u32 s58, s16, 3072
  s_add_u32 m0, s17, 3072
  s_nop 0
  buffer_load_dwordx4 v7, s[40:43], s58 offen  lds
  s_waitcnt vmcnt(0)
  s_add_u32 s16, s60, s5
  s_add_u32 s17, s59, s5
  s_add_u32 s58, s16, 0
  s_add_u32 m0, s17, 0
  s_nop 0
  buffer_load_dwordx4 v7, s[40:43], s58 offen  lds
  s_add_u32 s58, s16, 1024
  s_add_u32 m0, s17, 1024
  s_nop 0
  buffer_load_dwordx4 v7, s[40:43], s58 offen  lds
  s_add_u32 s58, s16, 2048
  s_add_u32 m0, s17, 2048
  s_nop 0
  buffer_load_dwordx4 v7, s[40:43], s58 offen  lds
  s_add_u32 s58, s16, 3072
  s_add_u32 m0, s17, 3072
  s_nop 0
  buffer_load_dwordx4 v7, s[40:43], s58 offen  lds
  s_barrier
  s_add_u32 s16, s60, s6
  s_add_u32 s17, s59, s6
  s_add_u32 s58, s16, 0
  s_add_u32 m0, s17, 0
  s_nop 0
  buffer_load_dwordx4 v7, s[40:43], s58 offen  lds
  s_add_u32 s58, s16, 1024
  s_add_u32 m0, s17, 1024
  s_nop 0
  buffer_load_dwordx4 v7, s[40:43], s58 offen  lds
  s_add_u32 s58, s16, 2048
  s_add_u32 m0, s17, 2048
  s_nop 0
  buffer_load_dwordx4 v7, s[40:43], s58 offen  lds
  s_add_u32 s58, s16, 3072
  s_add_u32 m0, s17, 3072
  s_nop 0
  buffer_load_dwordx4 v7, s[40:43], s58 offen  lds
  s_add_u32 s16, s60, s7
  s_add_u32 s17, s59, s7
  s_add_u32 s58, s16, 0
  s_add_u32 m0, s17, 0
  s_nop 0
  buffer_load_dwordx4 v7, s[40:43], s58 offen  lds
  s_add_u32 s58, s16, 1024
  s_add_u32 m0, s17, 1024
  s_nop 0
  buffer_load_dwordx4 v7, s[40:43], s58 offen  lds
  s_add_u32 s58, s16, 2048
  s_add_u32 m0, s17, 2048
  s_nop 0
  buffer_load_dwordx4 v7, s[40:43], s58 offen  lds
  s_add_u32 s58, s16, 3072
  s_add_u32 m0, s17, 3072
  s_nop 0
  buffer_load_dwordx4 v7, s[40:43], s58 offen  lds
  s_waitcnt vmcnt(8)
  s_barrier
  s_waitcnt vmcnt(4)
  s_barrier
  s_waitcnt vmcnt(0)
  s_barrier
  s_endpgm
L_comp:
  s_and_b32 s54, s51, 3
  s_lshr_b32 s55, s51, 2
  s_getpc_b64 s[62:63]
L_pcref:
  s_sub_u32 s62, s62, L_pcref-concat_heads__sliding_local_dilated__linear_attn_block__prompt_kernel
  s_subb_u32 s63, s63, 0
  s_lshl_b32 s57, s52, 3
  s_add_u32 s57, s57, s51
  s_lshl_b32 s57, s57, 7
  s_min_u32 s57, s57, (L_codeend-concat_heads__sliding_local_dilated__linear_attn_block__prompt_kernel-4)&0xfffffffc
  v_mov_b32 v7, s57
  s_mov_b64 exec, 1
  global_load_dword v161, v7, s[62:63]
  s_mov_b64 exec, -1
  v_and_b32 v7, 15, v0
  v_lshrrev_b32 v8, 4, v0
  v_lshrrev_b32 v9, 1, v7
  v_xor_b32 v9, v9, v8
  v_lshlrev_b32 v9, 4, v9
  v_lshl_add_u32 v1, v7, 7, v9
  v_lshrrev_b32 v9, 2, v7
  v_lshl_add_u32 v9, v8, 3, v9
  v_lshrrev_b32 v10, 1, v9
  v_and_b32 v10, 1, v10
  v_and_b32 v11, 1, v8
  v_lshl_or_b32 v10, v11, 1, v10
  v_xor_b32 v10, s54, v10
  v_lshlrev_b32 v10, 5, v10
  v_lshl_add_u32 v10, v9, 7, v10
  v_and_b32 v11, 3, v7
  v_lshl_add_u32 v2, v11, 3, v10
  v_add_u32 v2, 73728, v2
  v_mov_b32 v4, 1
  s_lshl_b32 s57, s48, 2
  s_add_u32 s57, s57, s54
  s_lshl_b32 s72, s57, 9
  s_lshl_b32 s58, s47, 17
  s_add_u32 s72, s72, s58
  s_lshl_b32 s58, s46, 21
  s_add_u32 s72, s72, s58
  s_mul_i32 s71, s57, 1152
  s_add_u32 s71, s71, 4194304
  s_lshl_b32 s56, s57, 7
  s_add_u32 s56, s56, 4292608
  s_lshl_b32 s22, s46, 7
  s_lshl_b32 s58, s47, 3
  s_add_u32 s22, s22, s58
  s_add_u32 s22, s22, s48
  s_lshl_b32 s22, s22, 7
  s_add_u32 s22, s22, 4259840
  s_lshl_b32 s58, s51, 2
  s_add_u32 s22, s22, s58
  v_and_b32 v9, 1, v8
  v_lshlrev_b32 v9, 14, v9
  v_lshrrev_b32 v10, 1, v8
  v_lshl_add_u32 v9, v10, 8, v9
  v_lshl_add_u32 v5, v7, 4, v9
  v_and_b32 v15, 7, v0
  v_lshlrev_b32 v15, 2, v15
  s_mov_b32 s61, 0
  s_mov_b32 s66, 0
  s_mov_b32 s67, 0
  v_mov_b32 v14, v2
  s_waitcnt lgkmcnt(0)
  s_cmp_eq_u32 s46, 0
  s_cselect_b32 s32, s8, s14
  s_cselect_b32 s33, s9, s15
  s_mov_b32 s34, 0x80000
  s_mov_b32 s35, 0x20000
  s_mov_b32 s36, s16
  s_mov_b32 s37, s17
  s_mov_b32 s38, 0x400000
  s_mov_b32 s39, 0x20000
  s_mov_b32 s40, s20
  s_mov_b32 s41, s21
  s_mov_b32 s42, 0x500000
  s_mov_b32 s43, 0x20000
  s_mov_b32 s44, s18
  s_mov_b32 s45, s19
  s_cmp_lg_u32 s51, 7
  s_cbranch_scc1 L_notlb
  v_mov_b32 v9, 0
  s_lshl_b32 s57, s49, 17
  s_lshl_b32 s58, s49, 16
  s_lshl_b32 s59, s46, 21
  s_add_u32 s58, s58, s59
  s_mov_b64 exec, 1
  buffer_load_dword v161, v9, s[40:43], s72 offen sc1
  buffer_load_dword v161, v9, s[40:43], s22 offen sc1
  buffer_load_dword v161, v9, s[36:39], s57 offen sc1
  buffer_load_dword v161, v9, s[32:35], 0 offen
  s_mov_b64 exec, -1
L_notlb:
  s_cmp_eq_u32 s46, 0
  s_cbranch_scc0 L_compB
  v_mov_b32 v136, v1
  s_cmp_eq_u32 s55, 0
  s_cbranch_scc1 L_h0ok
  v_or_b32 v10, 8, v7
  v_lshrrev_b32 v9, 1, v10
  v_xor_b32 v9, v9, v8
  v_lshlrev_b32 v9, 4, v9
  v_lshl_add_u32 v9, v10, 7, v9
  v_lshrrev_b32 v10, 3, v7
  v_lshlrev_b32 v10, 11, v10
  v_add_u32 v9, v9, v10
  v_add_u32 v136, 6144, v9
L_h0ok:
  s_lshl_b32 s57, s55, 13
  s_add_u32 s57, s57, 2048
  v_add_u32 v1, s57, v1
  v_xor_b32 v3, 64, v1
  v_mov_b32 v6, v1
  v_mov_b32 v13, v3
  v_mov_b32 v137, v136
  v_xor_b32 v138, 64, v136
  s_lshl_b32 s58, s55, 16
  s_add_u32 s72, s72, s58
  v_mov_b32 v16, 0
  v_mov_b32 v17, 0
  v_mov_b32 v18, 0
  v_mov_b32 v19, 0
  v_mov_b32 v20, 0
  v_mov_b32 v21, 0
  v_mov_b32 v22, 0
  v_mov_b32 v23, 0
  v_mov_b32 v24, 0
  v_mov_b32 v25, 0
  v_mov_b32 v26, 0
  v_mov_b32 v27, 0
  v_mov_b32 v28, 0
  v_mov_b32 v29, 0
  v_mov_b32 v30, 0
  v_mov_b32 v31, 0
  v_mov_b32 v32, 0
  v_mov_b32 v33, 0
  v_mov_b32 v34, 0
  v_mov_b32 v35, 0
  v_mov_b32 v36, 0
  v_mov_b32 v37, 0
  v_mov_b32 v38, 0
  v_mov_b32 v39, 0
  v_mov_b32 v40, 0
  v_mov_b32 v41, 0
  v_mov_b32 v42, 0
  v_mov_b32 v43, 0
  v_mov_b32 v44, 0
  v_mov_b32 v45, 0
  v_mov_b32 v46, 0
  v_mov_b32 v47, 0
  v_mov_b32 v48, 0
  v_mov_b32 v49, 0
  v_mov_b32 v50, 0
  v_mov_b32 v51, 0
  v_mov_b32 v52, 0
  v_mov_b32 v53, 0
  v_mov_b32 v54, 0
  v_mov_b32 v55, 0
  v_mov_b32 v56, 0
  v_mov_b32 v57, 0
  v_mov_b32 v58, 0
  v_mov_b32 v59, 0
  v_mov_b32 v60, 0
  v_mov_b32 v61, 0
  v_mov_b32 v62, 0
  v_mov_b32 v63, 0
  v_mov_b32 v64, 0
  v_mov_b32 v65, 0
  v_mov_b32 v66, 0
  v_mov_b32 v67, 0
  v_mov_b32 v68, 0
  v_mov_b32 v69, 0
  v_mov_b32 v70, 0
  v_mov_b32 v71, 0
  v_lshlrev_b32 v9, 2, v8
  v_sub_u32 v9, v7, v9
  s_mov_b32 s68, 0xf149f2ca
  v_mov_b32 v10, s68
  v_subrev_u32 v11, 0, v9
  v_and_b32 v12, 15, v11
  v_cmp_gt_u32 vcc, 8, v12
  s_nop 1
  v_cndmask_b32 v140, v10, 0, vcc
  v_cmp_gt_u32 vcc, 8, v11
  s_nop 1
  v_cndmask_b32 v144, v10, 0, vcc
  v_subrev_u32 v11, 1, v9
  v_and_b32 v12, 15, v11
  v_cmp_gt_u32 vcc, 8, v12
  s_nop 1
  v_cndmask_b32 v141, v10, 0, vcc
  v_cmp_gt_u32 vcc, 8, v11
  s_nop 1
  v_cndmask_b32 v145, v10, 0, vcc
  v_subrev_u32 v11, 2, v9
  v_and_b32 v12, 15, v11
  v_cmp_gt_u32 vcc, 8, v12
  s_nop 1
  v_cndmask_b32 v142, v10, 0, vcc
  v_cmp_gt_u32 vcc, 8, v11
  s_nop 1
  v_cndmask_b32 v146, v10, 0, vcc
  v_subrev_u32 v11, 3, v9
  v_and_b32 v12, 15, v11
  v_cmp_gt_u32 vcc, 8, v12
  s_nop 1
  v_cndmask_b32 v143, v10, 0, vcc
  v_cmp_gt_u32 vcc, 8, v11
  s_nop 1
  v_cndmask_b32 v147, v10, 0, vcc
  s_or_b32 s57, s47, s55
  s_cmp_eq_u32 s57, 0
  s_cbranch_scc1 L_m0
  v_mov_b32 v144, v140
  v_mov_b32 v145, v141
  v_mov_b32 v146, v142
  v_mov_b32 v147, v143
L_m0:
  v_cmp_lt_u32 s[62:63], 7, v7
  v_cmp_lt_u32 vcc, 1, v8
  s_nop 1
  v_cndmask_b32 v148, 0, -1, s[62:63]
  s_andn2_b64 s[64:65], vcc, s[62:63]
  v_mov_b32 v150, 0x3f803f80
  v_mov_b32 v151, 0x3f803f80
  v_cndmask_b32 v149, 0, -1, s[64:65]
  v_mov_b32 v152, 0x3f803f80
  v_mov_b32 v153, 0x3f803f80
  s_mov_b32 s68, 0x3eb8aa3b
  s_barrier
  ds_read_b64_tr_b16 v[96:97], v14 offset:4096
  ds_read_b64_tr_b16 v[98:99], v14 offset:4608
  ds_read_b64_tr_b16 v[100:101], v14 offset:8192
  ds_read_b64_tr_b16 v[102:103], v14 offset:8704
  ds_read_b64_tr_b16 v[92:93], v14 offset:0
  ds_read_b64_tr_b16 v[94:95], v14 offset:512
  ds_read_b128 v[72:75], v6 offset:0
  ds_read_b128 v[76:79], v6 offset:2048
  ds_read_b128 v[80:83], v6 offset:4096
  ds_read_b128 v[84:87], v6 offset:6144
  ds_read_b128 v[88:91], v137
L_s0A:
  s_waitcnt lgkmcnt(0)
  v_mfma_f32_16x16x32_bf16 v[32:35], v[96:99], v[72:75], v[32:35]
  s_add_u32 s67, s67, 12288
  s_cmp_eq_u32 s67, 86016
  v_mfma_f32_16x16x32_bf16 v[52:55], v[72:75], v[100:103], v[52:55]
  s_cselect_b32 s67, 0, s67
  v_add_u32 v14, s67, v2
  v_mfma_f32_16x16x32_bf16 v[16:19], v[92:95], v[72:75], v[16:19]
  s_barrier
  ds_read_b64_tr_b16 v[128:129], v14 offset:4096
  ds_read_b64_tr_b16 v[130:131], v14 offset:4608
  v_mfma_f32_16x16x32_bf16 v[36:39], v[96:99], v[76:79], v[36:39]
  ds_read_b64_tr_b16 v[132:133], v14 offset:8192
  v_mfma_f32_16x16x32_bf16 v[56:59], v[76:79], v[100:103], v[56:59]
  ds_read_b64_tr_b16 v[134:135], v14 offset:8704
  v_mfma_f32_16x16x32_bf16 v[20:23], v[92:95], v[76:79], v[20:23]
  ds_read_b64_tr_b16 v[124:125], v14 offset:0
  v_mfma_f32_16x16x32_bf16 v[40:43], v[96:99], v[80:83], v[40:43]
  ds_read_b64_tr_b16 v[126:127], v14 offset:512
  ds_read_b128 v[104:107], v13 offset:0
  v_mfma_f32_16x16x32_bf16 v[60:63], v[80:83], v[100:103], v[60:63]
  ds_read_b128 v[108:111], v13 offset:2048
  v_mfma_f32_16x16x32_bf16 v[24:27], v[92:95], v[80:83], v[24:27]
  ds_read_b128 v[112:115], v13 offset:4096
  v_mfma_f32_16x16x32_bf16 v[44:47], v[96:99], v[84:87], v[44:47]
  ds_read_b128 v[116:119], v13 offset:6144
  v_mfma_f32_16x16x32_bf16 v[64:67], v[84:87], v[100:103], v[64:67]
  ds_read_b128 v[120:123], v138
  v_mfma_f32_16x16x32_bf16 v[28:31], v[92:95], v[84:87], v[28:31]
  v_mfma_f32_16x16x32_bf16 v[48:51], v[96:99], v[88:91], v[48:51]
  v_mfma_f32_16x16x32_bf16 v[68:71], v[88:91], v[100:103], v[68:71]
L_s1A:
  s_waitcnt lgkmcnt(0)
  v_mfma_f32_16x16x32_bf16 v[32:35], v[128:131], v[104:107], v[32:35]
  s_add_u32 s67, s67, 12288
  s_cmp_eq_u32 s67, 86016
  s_cselect_b32 s67, 0, s67
  v_add_u32 v14, s67, v2
  s_add_u32 s66, s66, 18432
  s_cmp_eq_u32 s66, 73728
  v_mfma_f32_16x16x32_bf16 v[52:55], v[104:107], v[132:135], v[52:55]
  s_cselect_b32 s66, 0, s66
  v_add_u32 v6, s66, v1
  v_add_u32 v13, s66, v3
  v_add_u32 v137, s66, v136
  v_xor_b32 v138, 64, v137
  v_mfma_f32_16x16x32_bf16 v[16:19], v[124:127], v[104:107], v[16:19]
  s_barrier
  ds_read_b64_tr_b16 v[96:97], v14 offset:4096
  ds_read_b64_tr_b16 v[98:99], v14 offset:4608
  v_mfma_f32_16x16x32_bf16 v[36:39], v[128:131], v[108:111], v[36:39]
  ds_read_b64_tr_b16 v[100:101], v14 offset:8192
  v_mfma_f32_16x16x32_bf16 v[56:59], v[108:111], v[132:135], v[56:59]
  ds_read_b64_tr_b16 v[102:103], v14 offset:8704
  v_mfma_f32_16x16x32_bf16 v[20:23], v[124:127], v[108:111], v[20:23]
  ds_read_b64_tr_b16 v[92:93], v14 offset:0
  v_mfma_f32_16x16x32_bf16 v[40:43], v[128:131], v[112:115], v[40:43]
  ds_read_b64_tr_b16 v[94:95], v14 offset:512
  ds_read_b128 v[72:75], v6 offset:0
  v_mfma_f32_16x16x32_bf16 v[60:63], v[112:115], v[132:135], v[60:63]
  ds_read_b128 v[76:79], v6 offset:2048
  v_mfma_f32_16x16x32_bf16 v[24:27], v[124:127], v[112:115], v[24:27]
  ds_read_b128 v[80:83], v6 offset:4096
  v_mfma_f32_16x16x32_bf16 v[44:47], v[128:131], v[116:119], v[44:47]
  ds_read_b128 v[84:87], v6 offset:6144
  v_mfma_f32_16x16x32_bf16 v[64:67], v[116:119], v[132:135], v[64:67]
  ds_read_b128 v[88:91], v137
  v_mfma_f32_16x16x32_bf16 v[28:31], v[124:127], v[116:119], v[28:31]
  v_mfma_f32_16x16x32_bf16 v[48:51], v[128:131], v[120:123], v[48:51]
  v_mfma_f32_16x16x32_bf16 v[68:71], v[120:123], v[132:135], v[68:71]
  s_add_u32 s61, s61, 1
  s_cmp_lt_u32 s61, 8
  s_cbranch_scc1 L_s0A
  global_load_dword v160, v15, s[44:45] sc1
  s_waitcnt lgkmcnt(0)
  v_cvt_pk_bf16_f32 v72, v32, v33
  v_cvt_pk_bf16_f32 v73, v34, v35
  v_cvt_pk_bf16_f32 v106, v52, v53
  v_cvt_pk_bf16_f32 v107, v54, v55
  v_cvt_pk_bf16_f32 v120, v16, v17
  v_cvt_pk_bf16_f32 v121, v18, v19
  v_and_b32 v88, v120, v148
  v_and_b32 v89, v121, v148
  v_xor_b32 v90, v120, v88
  v_xor_b32 v91, v121, v89
  v_cvt_pk_bf16_f32 v76, v36, v37
  v_cvt_pk_bf16_f32 v77, v38, v39
  v_cvt_pk_bf16_f32 v112, v56, v57
  v_cvt_pk_bf16_f32 v113, v58, v59
  v_cvt_pk_bf16_f32 v122, v20, v21
  v_cvt_pk_bf16_f32 v123, v22, v23
  v_and_b32 v92, v122, v148
  v_and_b32 v93, v123, v148
  v_xor_b32 v94, v122, v92
  v_xor_b32 v95, v123, v93
  v_cvt_pk_bf16_f32 v80, v40, v41
  v_cvt_pk_bf16_f32 v81, v42, v43
  v_cvt_pk_bf16_f32 v108, v60, v61
  v_cvt_pk_bf16_f32 v109, v62, v63
  v_cvt_pk_bf16_f32 v120, v24, v25
  v_cvt_pk_bf16_f32 v121, v26, v27
  v_and_b32 v96, v120, v148
  v_and_b32 v97, v121, v148
  v_xor_b32 v98, v120, v96
  v_xor_b32 v99, v121, v97
  v_cvt_pk_bf16_f32 v84, v44, v45
  v_cvt_pk_bf16_f32 v85, v46, v47
  v_cvt_pk_bf16_f32 v114, v64, v65
  v_cvt_pk_bf16_f32 v115, v66, v67
  v_cvt_pk_bf16_f32 v122, v28, v29
  v_cvt_pk_bf16_f32 v123, v30, v31
  v_and_b32 v100, v122, v148
  v_and_b32 v101, v123, v148
  v_xor_b32 v102, v122, v100
  v_xor_b32 v103, v123, v101
  v_cvt_pk_bf16_f32 v116, v48, v49
  v_cvt_pk_bf16_f32 v117, v50, v51
  v_cvt_pk_bf16_f32 v110, v68, v69
  v_cvt_pk_bf16_f32 v111, v70, v71
  s_nop 1
  v_mov_b32_dpp v118, v116 row_ror:8 row_mask:0xf bank_mask:0xf
  v_mov_b32_dpp v119, v117 row_ror:8 row_mask:0xf bank_mask:0xf
  v_mov_b32 v104, v110
  v_mov_b32 v105, v111
  v_mov_b32 v120, v110
  v_mov_b32 v121, v111
  s_nop 1
  v_permlane32_swap_b32 v104, v120
  v_permlane32_swap_b32 v105, v121
  v_cndmask_b32 v74, v72, v118, s[62:63]
  v_cndmask_b32 v75, v73, v119, s[62:63]
  v_cndmask_b32 v78, v76, v116, s[62:63]
  v_cndmask_b32 v79, v77, v117, s[62:63]
  v_cndmask_b32 v82, v80, v72, s[62:63]
  v_cndmask_b32 v83, v81, v73, s[62:63]
  v_cndmask_b32 v86, v84, v76, s[62:63]
  v_cndmask_b32 v87, v85, v77, s[62:63]
  s_nop 1
  v_mfma_f32_16x16x32_bf16 v[16:19], v[72:75], v[88:91], v[144:147]
  v_mfma_f32_16x16x32_bf16 v[20:23], v[76:79], v[92:95], v[144:147]
  v_mfma_f32_16x16x32_bf16 v[24:27], v[80:83], v[96:99], v[140:143]
  v_mfma_f32_16x16x32_bf16 v[28:31], v[84:87], v[100:103], v[140:143]
  s_nop 7
  v_max3_f32 v32, v16, v17, v18
  v_max3_f32 v33, v20, v21, v22
  v_max3_f32 v34, v24, v25, v26
  v_max3_f32 v35, v28, v29, v30
  v_max_f32 v32, v32, v19
  v_max_f32 v33, v33, v23
  v_max_f32 v34, v34, v27
  v_max_f32 v35, v35, v31
  s_nop 0
  v_permlane32_swap_b32 v32, v33
  v_permlane32_swap_b32 v34, v35
  v_max_f32 v32, v32, v33
  v_max_f32 v34, v34, v35
  s_nop 1
  v_permlane16_swap_b32 v32, v34
  v_max_f32 v32, v32, v34
  v_mul_f32 v32, s68, v32
  v_mov_b32 v34, v32
  s_nop 1
  v_permlane16_swap_b32 v32, v34
  v_mov_b32 v33, v32
  v_mov_b32 v35, v34
  s_nop 0
  v_permlane32_swap_b32 v32, v33
  v_permlane32_swap_b32 v34, v35
  v_fma_f32 v16, v16, s68, -v32
  v_fma_f32 v17, v17, s68, -v32
  v_fma_f32 v18, v18, s68, -v32
  v_fma_f32 v19, v19, s68, -v32
  v_fma_f32 v20, v20, s68, -v33
  v_fma_f32 v21, v21, s68, -v33
  v_fma_f32 v22, v22, s68, -v33
  v_fma_f32 v23, v23, s68, -v33
  v_fma_f32 v24, v24, s68, -v34
  v_fma_f32 v25, v25, s68, -v34
  v_fma_f32 v26, v26, s68, -v34
  v_fma_f32 v27, v27, s68, -v34
  v_fma_f32 v28, v28, s68, -v35
  v_fma_f32 v29, v29, s68, -v35
  v_fma_f32 v30, v30, s68, -v35
  v_fma_f32 v31, v31, s68, -v35
  v_exp_f32 v16, v16
  v_exp_f32 v17, v17
  v_exp_f32 v18, v18
  v_exp_f32 v19, v19
  v_exp_f32 v20, v20
  v_exp_f32 v21, v21
  v_exp_f32 v22, v22
  v_exp_f32 v23, v23
  v_exp_f32 v24, v24
  v_exp_f32 v25, v25
  v_exp_f32 v26, v26
  v_exp_f32 v27, v27
  v_exp_f32 v28, v28
  v_exp_f32 v29, v29
  v_exp_f32 v30, v30
  v_exp_f32 v31, v31
  v_cvt_pk_bf16_f32 v36, v16, v17
  v_cvt_pk_bf16_f32 v37, v18, v19
  v_and_b32 v40, v36, v149
  v_and_b32 v41, v37, v149
  v_xor_b32 v42, v36, v40
  v_xor_b32 v43, v37, v41
  v_cvt_pk_bf16_f32 v38, v20, v21
  v_cvt_pk_bf16_f32 v39, v22, v23
  v_and_b32 v44, v38, v149
  v_and_b32 v45, v39, v149
  v_xor_b32 v46, v38, v44
  v_xor_b32 v47, v39, v45
  v_cvt_pk_bf16_f32 v36, v24, v25
  v_cvt_pk_bf16_f32 v37, v26, v27
  v_and_b32 v48, v36, v149
  v_and_b32 v49, v37, v149
  v_xor_b32 v50, v36, v48
  v_xor_b32 v51, v37, v49
  v_cvt_pk_bf16_f32 v38, v28, v29
  v_cvt_pk_bf16_f32 v39, v30, v31
  v_and_b32 v52, v38, v149
  v_and_b32 v53, v39, v149
  v_xor_b32 v54, v38, v52
  v_xor_b32 v55, v39, v53
  s_nop 1
  v_mfma_f32_16x16x32_bf16 v[88:91], v[150:153], v[40:43], 0
  v_mfma_f32_16x16x32_bf16 v[72:75], v[104:107], v[40:43], 0
  v_mfma_f32_16x16x32_bf16 v[92:95], v[150:153], v[44:47], 0
  v_mfma_f32_16x16x32_bf16 v[76:79], v[110:113], v[44:47], 0
  v_mfma_f32_16x16x32_bf16 v[96:99], v[150:153], v[48:51], 0
  v_mfma_f32_16x16x32_bf16 v[80:83], v[106:109], v[48:51], 0
  v_mfma_f32_16x16x32_bf16 v[100:103], v[150:153], v[52:55], 0
  v_mfma_f32_16x16x32_bf16 v[84:87], v[112:115], v[52:55], 0
  s_nop 4
  v_rcp_f32 v88, v88
  v_rcp_f32 v92, v92
  v_rcp_f32 v96, v96
  v_rcp_f32 v100, v100
  v_pk_mul_f32 v[72:73], v[72:73], v[88:89] op_sel_hi:[1,0]
  v_pk_mul_f32 v[74:75], v[74:75], v[88:89] op_sel_hi:[1,0]
  v_pk_mul_f32 v[76:77], v[76:77], v[92:93] op_sel_hi:[1,0]
  v_pk_mul_f32 v[78:79], v[78:79], v[92:93] op_sel_hi:[1,0]
  v_pk_mul_f32 v[80:81], v[80:81], v[96:97] op_sel_hi:[1,0]
  v_pk_mul_f32 v[82:83], v[82:83], v[96:97] op_sel_hi:[1,0]
  v_pk_mul_f32 v[84:85], v[84:85], v[100:101] op_sel_hi:[1,0]
  v_pk_mul_f32 v[86:87], v[86:87], v[100:101] op_sel_hi:[1,0]
  v_cvt_pk_bf16_f32 v16, v72, v73
  v_cvt_pk_bf16_f32 v17, v74, v75
  v_cvt_pk_bf16_f32 v18, v76, v77
  v_cvt_pk_bf16_f32 v19, v78, v79
  v_cvt_pk_bf16_f32 v20, v80, v81
  v_cvt_pk_bf16_f32 v21, v82, v83
  v_cvt_pk_bf16_f32 v22, v84, v85
  v_cvt_pk_bf16_f32 v23, v86, v87
  s_nop 1
  v_permlane16_swap_b32 v16, v18
  v_permlane16_swap_b32 v17, v19
  v_permlane16_swap_b32 v20, v22
  v_permlane16_swap_b32 v21, v23
  s_add_u32 s57, s72, 0
  buffer_store_dwordx4 v[16:19], v5, s[40:43], s57 offen sc1
  s_add_u32 s57, s72, 32768
  buffer_store_dwordx4 v[20:23], v5, s[40:43], s57 offen sc1
  s_branch L_phase2
L_compB:
  s_mov_b32 s68, 0x358637bd
  s_mov_b32 s69, 0x3fb8aa3b
  s_mov_b32 s70, 0xb5c1a2a0
  v_mov_b32 v162, s70
  v_mov_b32 v163, s69
  v_add_u32 v1, 2048, v1
  v_xor_b32 v3, 64, v1
  v_mov_b32 v6, v1
  v_mov_b32 v13, v3
  v_mov_b32 v16, s68
  v_mov_b32 v17, s68
  v_mov_b32 v18, s68
  v_mov_b32 v19, s68
  v_mov_b32 v20, s68
  v_mov_b32 v21, s68
  v_mov_b32 v22, s68
  v_mov_b32 v23, s68
  v_mov_b32 v24, s68
  v_mov_b32 v25, s68
  v_mov_b32 v26, s68
  v_mov_b32 v27, s68
  v_mov_b32 v28, s68
  v_mov_b32 v29, s68
  v_mov_b32 v30, s68
  v_mov_b32 v31, s68
  v_mov_b32 v32, s68
  v_mov_b32 v33, s68
  v_mov_b32 v34, s68
  v_mov_b32 v35, s68
  v_mov_b32 v36, s68
  v_mov_b32 v37, s68
  v_mov_b32 v38, s68
  v_mov_b32 v39, s68
  v_mov_b32 v40, s68
  v_mov_b32 v41, s68
  v_mov_b32 v42, s68
  v_mov_b32 v43, s68
  v_mov_b32 v44, s68
  v_mov_b32 v45, s68
  v_mov_b32 v46, s68
  v_mov_b32 v47, s68
  s_cmp_lg_u32 s55, 0
  s_cbranch_scc1 L_compQ
  s_cmp_lg_u32 s47, 0
  s_cbranch_scc1 L_nozero
  v_mov_b32 v8, 0
  v_mov_b32 v9, 0
  v_mov_b32 v10, 0
  v_mov_b32 v11, 0
  v_lshlrev_b32 v7, 4, v0
  buffer_store_dwordx4 v[8:11], v7, s[40:43], s71 offen sc1
  s_mov_b64 exec, 0xff
  buffer_store_dwordx4 v[8:11], v7, s[40:43], s71 offen offset:1024 sc1
  s_mov_b64 exec, -1
  s_lshl_b32 s57, s48, 2
  s_add_u32 s57, s57, s54
  s_mul_i32 s57, s57, 1152
  s_add_u32 s57, s57, 4259840
  v_lshlrev_b32 v7, 7, v0
  s_mov_b64 exec, 0x1ff
  buffer_store_dword v8, v7, s[40:43], s57 offen sc1
  s_mov_b64 exec, -1
L_nozero:
  v_mov_b32 v48, 0
  v_mov_b32 v49, 0
  v_mov_b32 v50, 0
  v_mov_b32 v51, 0
  v_mov_b32 v52, 0
  v_mov_b32 v53, 0
  v_mov_b32 v54, 0
  v_mov_b32 v55, 0
  v_mov_b32 v56, 0
  v_mov_b32 v57, 0
  v_mov_b32 v58, 0
  v_mov_b32 v59, 0
  v_mov_b32 v60, 0
  v_mov_b32 v61, 0
  v_mov_b32 v62, 0
  v_mov_b32 v63, 0
  v_mov_b32 v64, 0
  v_mov_b32 v65, 0
  v_mov_b32 v66, 0
  v_mov_b32 v67, 0
  v_mov_b32 v68, 0
  v_mov_b32 v69, 0
  v_mov_b32 v70, 0
  v_mov_b32 v71, 0
  v_mov_b32 v72, 0
  v_mov_b32 v73, 0
  v_mov_b32 v74, 0
  v_mov_b32 v75, 0
  v_mov_b32 v76, 0
  v_mov_b32 v77, 0
  v_mov_b32 v78, 0
  v_mov_b32 v79, 0
  v_mov_b32 v164, 0x3f803f80
  v_mov_b32 v165, 0x3f803f80
  v_mov_b32 v166, 0x3f803f80
  v_mov_b32 v167, 0x3f803f80
  s_barrier
  ds_read_b64_tr_b16 v[112:113], v14 offset:4096
  ds_read_b64_tr_b16 v[114:115], v14 offset:4608
  ds_read_b64_tr_b16 v[116:117], v14 offset:8192
  ds_read_b64_tr_b16 v[118:119], v14 offset:8704
  ds_read_b128 v[80:83], v6 offset:0
  ds_read_b128 v[84:87], v6 offset:2048
  ds_read_b128 v[88:91], v6 offset:4096
  ds_read_b128 v[92:95], v6 offset:6144
  ds_read_b128 v[96:99], v6 offset:8192
  ds_read_b128 v[100:103], v6 offset:10240
  ds_read_b128 v[104:107], v6 offset:12288
  ds_read_b128 v[108:111], v6 offset:14336
L_s0K:
  s_waitcnt lgkmcnt(0)
  v_mfma_f32_16x16x32_bf16 v[16:19], v[80:83], v[112:115], v[16:19]
  s_add_u32 s67, s67, 12288
  s_cmp_eq_u32 s67, 86016
  v_mfma_f32_16x16x32_bf16 v[48:51], v[80:83], v[116:119], v[48:51]
  s_cselect_b32 s67, 0, s67
  v_add_u32 v14, s67, v2
  v_mfma_f32_16x16x32_bf16 v[20:23], v[84:87], v[112:115], v[20:23]
  s_barrier
  ds_read_b64_tr_b16 v[152:153], v14 offset:4096
  ds_read_b64_tr_b16 v[154:155], v14 offset:4608
  v_mfma_f32_16x16x32_bf16 v[52:55], v[84:87], v[116:119], v[52:55]
  ds_read_b64_tr_b16 v[156:157], v14 offset:8192
  v_mfma_f32_16x16x32_bf16 v[24:27], v[88:91], v[112:115], v[24:27]
  ds_read_b64_tr_b16 v[158:159], v14 offset:8704
  v_mfma_f32_16x16x32_bf16 v[56:59], v[88:91], v[116:119], v[56:59]
  ds_read_b128 v[120:123], v13 offset:0
  v_mfma_f32_16x16x32_bf16 v[28:31], v[92:95], v[112:115], v[28:31]
  ds_read_b128 v[124:127], v13 offset:2048
  v_mfma_f32_16x16x32_bf16 v[60:63], v[92:95], v[116:119], v[60:63]
  ds_read_b128 v[128:131], v13 offset:4096
  v_mfma_f32_16x16x32_bf16 v[32:35], v[96:99], v[112:115], v[32:35]
  ds_read_b128 v[132:135], v13 offset:6144
  v_mfma_f32_16x16x32_bf16 v[64:67], v[96:99], v[116:119], v[64:67]
  ds_read_b128 v[136:139], v13 offset:8192
  v_mfma_f32_16x16x32_bf16 v[36:39], v[100:103], v[112:115], v[36:39]
  ds_read_b128 v[140:143], v13 offset:10240
  v_mfma_f32_16x16x32_bf16 v[68:71], v[100:103], v[116:119], v[68:71]
  ds_read_b128 v[144:147], v13 offset:12288
  v_mfma_f32_16x16x32_bf16 v[40:43], v[104:107], v[112:115], v[40:43]
  ds_read_b128 v[148:151], v13 offset:14336
  v_mfma_f32_16x16x32_bf16 v[72:75], v[104:107], v[116:119], v[72:75]
  v_mfma_f32_16x16x32_bf16 v[44:47], v[108:111], v[112:115], v[44:47]
  v_mfma_f32_16x16x32_bf16 v[76:79], v[108:111], v[116:119], v[76:79]
L_s1K:
  s_waitcnt lgkmcnt(0)
  v_mfma_f32_16x16x32_bf16 v[16:19], v[120:123], v[152:155], v[16:19]
  s_add_u32 s67, s67, 12288
  s_cmp_eq_u32 s67, 86016
  s_cselect_b32 s67, 0, s67
  v_add_u32 v14, s67, v2
  s_add_u32 s66, s66, 18432
  v_mfma_f32_16x16x32_bf16 v[48:51], v[120:123], v[156:159], v[48:51]
  s_cmp_eq_u32 s66, 73728
  s_cselect_b32 s66, 0, s66
  v_add_u32 v6, s66, v1
  v_add_u32 v13, s66, v3
  v_mfma_f32_16x16x32_bf16 v[20:23], v[124:127], v[152:155], v[20:23]
  s_barrier
  ds_read_b64_tr_b16 v[112:113], v14 offset:4096
  ds_read_b64_tr_b16 v[114:115], v14 offset:4608
  v_mfma_f32_16x16x32_bf16 v[52:55], v[124:127], v[156:159], v[52:55]
  ds_read_b64_tr_b16 v[116:117], v14 offset:8192
  v_mfma_f32_16x16x32_bf16 v[24:27], v[128:131], v[152:155], v[24:27]
  ds_read_b64_tr_b16 v[118:119], v14 offset:8704
  v_mfma_f32_16x16x32_bf16 v[56:59], v[128:131], v[156:159], v[56:59]
  ds_read_b128 v[80:83], v6 offset:0
  v_mfma_f32_16x16x32_bf16 v[28:31], v[132:135], v[152:155], v[28:31]
  ds_read_b128 v[84:87], v6 offset:2048
  v_mfma_f32_16x16x32_bf16 v[60:63], v[132:135], v[156:159], v[60:63]
  ds_read_b128 v[88:91], v6 offset:4096
  v_mfma_f32_16x16x32_bf16 v[32:35], v[136:139], v[152:155], v[32:35]
  ds_read_b128 v[92:95], v6 offset:6144
  v_mfma_f32_16x16x32_bf16 v[64:67], v[136:139], v[156:159], v[64:67]
  ds_read_b128 v[96:99], v6 offset:8192
  v_mfma_f32_16x16x32_bf16 v[36:39], v[140:143], v[152:155], v[36:39]
  ds_read_b128 v[100:103], v6 offset:10240
  v_mfma_f32_16x16x32_bf16 v[68:71], v[140:143], v[156:159], v[68:71]
  ds_read_b128 v[104:107], v6 offset:12288
  v_mfma_f32_16x16x32_bf16 v[40:43], v[144:147], v[152:155], v[40:43]
  ds_read_b128 v[108:111], v6 offset:14336
  v_mfma_f32_16x16x32_bf16 v[72:75], v[144:147], v[156:159], v[72:75]
  v_mfma_f32_16x16x32_bf16 v[44:47], v[148:151], v[152:155], v[44:47]
  v_mfma_f32_16x16x32_bf16 v[76:79], v[148:151], v[156:159], v[76:79]
  s_or_b32 s57, s61, s47
  s_cmp_lg_u32 s57, 0
  s_cbranch_scc1 L_noack
  s_waitcnt vmcnt(0)
  s_lshl_b32 s57, s48, 2
  s_add_u32 s57, s57, s54
  v_mov_b32 v11, s57
  s_mov_b64 exec, 1
  global_store_byte v11, v4, s[44:45] sc1
  s_mov_b64 exec, -1
L_noack:
  s_add_u32 s61, s61, 1
  s_cmp_lt_u32 s61, 8
  s_cbranch_scc1 L_s0K
  global_load_dword v160, v15, s[44:45] sc1
  s_waitcnt lgkmcnt(0)
  s_setprio 2
  v_cvt_pk_bf16_f32 v96, v48, v49
  v_cvt_pk_bf16_f32 v97, v50, v51
  v_cvt_pk_bf16_f32 v98, v52, v53
  v_cvt_pk_bf16_f32 v99, v54, v55
  v_cvt_pk_bf16_f32 v100, v56, v57
  v_cvt_pk_bf16_f32 v101, v58, v59
  v_cvt_pk_bf16_f32 v102, v60, v61
  v_cvt_pk_bf16_f32 v103, v62, v63
  v_cvt_pk_bf16_f32 v104, v64, v65
  v_cvt_pk_bf16_f32 v105, v66, v67
  v_cvt_pk_bf16_f32 v106, v68, v69
  v_cvt_pk_bf16_f32 v107, v70, v71
  v_cvt_pk_bf16_f32 v108, v72, v73
  v_cvt_pk_bf16_f32 v109, v74, v75
  v_cvt_pk_bf16_f32 v110, v76, v77
  v_cvt_pk_bf16_f32 v111, v78, v79
  v_pk_fma_f32 v[112:113], v[16:17], v[162:163], v[162:163] op_sel:[0,1,0] op_sel_hi:[1,1,0]
  v_pk_fma_f32 v[114:115], v[18:19], v[162:163], v[162:163] op_sel:[0,1,0] op_sel_hi:[1,1,0]
  v_pk_fma_f32 v[116:117], v[20:21], v[162:163], v[162:163] op_sel:[0,1,0] op_sel_hi:[1,1,0]
  v_pk_fma_f32 v[118:119], v[22:23], v[162:163], v[162:163] op_sel:[0,1,0] op_sel_hi:[1,1,0]
  v_pk_fma_f32 v[120:121], v[24:25], v[162:163], v[162:163] op_sel:[0,1,0] op_sel_hi:[1,1,0]
  v_pk_fma_f32 v[122:123], v[26:27], v[162:163], v[162:163] op_sel:[0,1,0] op_sel_hi:[1,1,0]
  v_pk_fma_f32 v[124:125], v[28:29], v[162:163], v[162:163] op_sel:[0,1,0] op_sel_hi:[1,1,0]
  v_pk_fma_f32 v[126:127], v[30:31], v[162:163], v[162:163] op_sel:[0,1,0] op_sel_hi:[1,1,0]
  v_pk_fma_f32 v[128:129], v[32:33], v[162:163], v[162:163] op_sel:[0,1,0] op_sel_hi:[1,1,0]
  v_pk_fma_f32 v[130:131], v[34:35], v[162:163], v[162:163] op_sel:[0,1,0] op_sel_hi:[1,1,0]
  v_pk_fma_f32 v[132:133], v[36:37], v[162:163], v[162:163] op_sel:[0,1,0] op_sel_hi:[1,1,0]
  v_pk_fma_f32 v[134:135], v[38:39], v[162:163], v[162:163] op_sel:[0,1,0] op_sel_hi:[1,1,0]
  v_pk_fma_f32 v[136:137], v[40:41], v[162:163], v[162:163] op_sel:[0,1,0] op_sel_hi:[1,1,0]
  v_pk_fma_f32 v[138:139], v[42:43], v[162:163], v[162:163] op_sel:[0,1,0] op_sel_hi:[1,1,0]
  v_pk_fma_f32 v[140:141], v[44:45], v[162:163], v[162:163] op_sel:[0,1,0] op_sel_hi:[1,1,0]
  v_pk_fma_f32 v[142:143], v[46:47], v[162:163], v[162:163] op_sel:[0,1,0] op_sel_hi:[1,1,0]
  v_exp_f32 v112, v112 clamp
  v_exp_f32 v113, v113 clamp
  v_exp_f32 v114, v114 clamp
  v_exp_f32 v115, v115 clamp
  v_exp_f32 v116, v116 clamp
  v_exp_f32 v117, v117 clamp
  v_exp_f32 v118, v118 clamp
  v_exp_f32 v119, v119 clamp
  v_exp_f32 v120, v120 clamp
  v_exp_f32 v121, v121 clamp
  v_exp_f32 v122, v122 clamp
  v_exp_f32 v123, v123 clamp
  v_exp_f32 v124, v124 clamp
  v_exp_f32 v125, v125 clamp
  v_exp_f32 v126, v126 clamp
  v_exp_f32 v127, v127 clamp
  v_exp_f32 v128, v128 clamp
  v_exp_f32 v129, v129 clamp
  v_exp_f32 v130, v130 clamp
  v_exp_f32 v131, v131 clamp
  v_exp_f32 v132, v132 clamp
  v_exp_f32 v133, v133 clamp
  v_exp_f32 v134, v134 clamp
  v_exp_f32 v135, v135 clamp
  v_exp_f32 v136, v136 clamp
  v_exp_f32 v137, v137 clamp
  v_exp_f32 v138, v138 clamp
  v_exp_f32 v139, v139 clamp
  v_exp_f32 v140, v140 clamp
  v_exp_f32 v141, v141 clamp
  v_exp_f32 v142, v142 clamp
  v_exp_f32 v143, v143 clamp
  v_max_f32 v16, s68, v16
  v_max_f32 v17, s68, v17
  v_max_f32 v18, s68, v18
  v_max_f32 v19, s68, v19
  v_max_f32 v20, s68, v20
  v_max_f32 v21, s68, v21
  v_max_f32 v22, s68, v22
  v_max_f32 v23, s68, v23
  v_max_f32 v24, s68, v24
  v_max_f32 v25, s68, v25
  v_max_f32 v26, s68, v26
  v_max_f32 v27, s68, v27
  v_max_f32 v28, s68, v28
  v_max_f32 v29, s68, v29
  v_max_f32 v30, s68, v30
  v_max_f32 v31, s68, v31
  v_max_f32 v32, s68, v32
  v_max_f32 v33, s68, v33
  v_max_f32 v34, s68, v34
  v_max_f32 v35, s68, v35
  v_max_f32 v36, s68, v36
  v_max_f32 v37, s68, v37
  v_max_f32 v38, s68, v38
  v_max_f32 v39, s68, v39
  v_max_f32 v40, s68, v40
  v_max_f32 v41, s68, v41
  v_max_f32 v42, s68, v42
  v_max_f32 v43, s68, v43
  v_max_f32 v44, s68, v44
  v_max_f32 v45, s68, v45
  v_max_f32 v46, s68, v46
  v_max_f32 v47, s68, v47
  v_pk_add_f32 v[16:17], v[16:17], v[112:113]
  v_pk_add_f32 v[18:19], v[18:19], v[114:115]
  v_pk_add_f32 v[20:21], v[20:21], v[116:117]
  v_pk_add_f32 v[22:23], v[22:23], v[118:119]
  v_pk_add_f32 v[24:25], v[24:25], v[120:121]
  v_pk_add_f32 v[26:27], v[26:27], v[122:123]
  v_pk_add_f32 v[28:29], v[28:29], v[124:125]
  v_pk_add_f32 v[30:31], v[30:31], v[126:127]
  v_pk_add_f32 v[32:33], v[32:33], v[128:129]
  v_pk_add_f32 v[34:35], v[34:35], v[130:131]
  v_pk_add_f32 v[36:37], v[36:37], v[132:133]
  v_pk_add_f32 v[38:39], v[38:39], v[134:135]
  v_pk_add_f32 v[40:41], v[40:41], v[136:137]
  v_pk_add_f32 v[42:43], v[42:43], v[138:139]
  v_pk_add_f32 v[44:45], v[44:45], v[140:141]
  v_pk_add_f32 v[46:47], v[46:47], v[142:143]
  v_cvt_pk_bf16_f32 v80, v16, v17
  v_cvt_pk_bf16_f32 v81, v18, v19
  v_cvt_pk_bf16_f32 v82, v20, v21
  v_cvt_pk_bf16_f32 v83, v22, v23
  v_cvt_pk_bf16_f32 v84, v24, v25
  v_cvt_pk_bf16_f32 v85, v26, v27
  v_cvt_pk_bf16_f32 v86, v28, v29
  v_cvt_pk_bf16_f32 v87, v30, v31
  v_cvt_pk_bf16_f32 v88, v32, v33
  v_cvt_pk_bf16_f32 v89, v34, v35
  v_cvt_pk_bf16_f32 v90, v36, v37
  v_cvt_pk_bf16_f32 v91, v38, v39
  v_cvt_pk_bf16_f32 v92, v40, v41
  v_cvt_pk_bf16_f32 v93, v42, v43
  v_cvt_pk_bf16_f32 v94, v44, v45
  v_cvt_pk_bf16_f32 v95, v46, v47
  s_nop 1
  v_mfma_f32_16x16x32_bf16 v[144:147], v[96:99], v[80:83], 0
  v_mfma_f32_16x16x32_bf16 v[148:151], v[164:167], v[80:83], 0
  v_mfma_f32_16x16x32_bf16 v[144:147], v[100:103], v[84:87], v[144:147]
  v_mfma_f32_16x16x32_bf16 v[148:151], v[164:167], v[84:87], v[148:151]
  v_mfma_f32_16x16x32_bf16 v[144:147], v[104:107], v[88:91], v[144:147]
  v_mfma_f32_16x16x32_bf16 v[148:151], v[164:167], v[88:91], v[148:151]
  v_mfma_f32_16x16x32_bf16 v[144:147], v[108:111], v[92:95], v[144:147]
  v_mfma_f32_16x16x32_bf16 v[148:151], v[164:167], v[92:95], v[148:151]
  v_and_b32 v7, 15, v0
  v_lshlrev_b32 v7, 2, v7
  v_lshrrev_b32 v8, 5, v0
  v_lshl_add_u32 v7, v8, 8, v7
  v_bfe_u32 v8, v0, 4, 1
  v_lshl_add_u32 v7, v8, 9, v7
  s_mov_b32 s58, 0x01010101
L_icB:
  s_waitcnt vmcnt(0)
  v_cmp_ne_u32 vcc, s58, v160
  s_nop 3
  s_cmp_eq_u64 vcc, 0
  s_cbranch_scc1 L_idB
  s_add_u32 s73, s73, 1
  s_cmp_gt_u32 s73, 0x40000
  s_cbranch_scc1 L_idB
  s_sleep 4
  global_load_dword v160, v15, s[44:45] sc1
  s_branch L_icB
L_idB:
  s_nop 2
  buffer_atomic_add_f32 v144, v7, s[40:43], s71 offen offset:0
  buffer_atomic_add_f32 v145, v7, s[40:43], s71 offen offset:64
  buffer_atomic_add_f32 v146, v7, s[40:43], s71 offen offset:128
  buffer_atomic_add_f32 v147, v7, s[40:43], s71 offen offset:192
  s_mov_b64 exec, 0xffff
  buffer_atomic_add_f32 v148, v7, s[40:43], s71 offen offset:1024
  s_mov_b64 exec, -1
  v_mov_b32 v8, 0
  s_waitcnt vmcnt(0)
  s_mov_b64 exec, 1
  buffer_atomic_add v4, v8, s[40:43], s56 offen
  s_mov_b64 exec, -1
  s_mov_b32 s61, 99
  s_setprio 0
  s_branch L_phase2
L_compQ:
  s_barrier
  ds_read_b64_tr_b16 v[112:113], v14 offset:0
  ds_read_b64_tr_b16 v[114:115], v14 offset:512
  ds_read_b128 v[80:83], v6 offset:0
  ds_read_b128 v[84:87], v6 offset:2048
  ds_read_b128 v[88:91], v6 offset:4096
  ds_read_b128 v[92:95], v6 offset:6144
  ds_read_b128 v[96:99], v6 offset:8192
  ds_read_b128 v[100:103], v6 offset:10240
  ds_read_b128 v[104:107], v6 offset:12288
  ds_read_b128 v[108:111], v6 offset:14336
L_s0Q:
  s_waitcnt lgkmcnt(0)
  v_mfma_f32_16x16x32_bf16 v[16:19], v[112:115], v[80:83], v[16:19]
  s_add_u32 s67, s67, 12288
  s_cmp_eq_u32 s67, 86016
  s_cselect_b32 s67, 0, s67
  v_add_u32 v14, s67, v2
  v_mfma_f32_16x16x32_bf16 v[20:23], v[112:115], v[84:87], v[20:23]
  s_barrier
  ds_read_b64_tr_b16 v[152:153], v14 offset:0
  ds_read_b64_tr_b16 v[154:155], v14 offset:512
  ds_read_b128 v[120:123], v13 offset:0
  v_mfma_f32_16x16x32_bf16 v[24:27], v[112:115], v[88:91], v[24:27]
  ds_read_b128 v[124:127], v13 offset:2048
  ds_read_b128 v[128:131], v13 offset:4096
  v_mfma_f32_16x16x32_bf16 v[28:31], v[112:115], v[92:95], v[28:31]
  ds_read_b128 v[132:135], v13 offset:6144
  ds_read_b128 v[136:139], v13 offset:8192
  ds_read_b128 v[140:143], v13 offset:10240
  v_mfma_f32_16x16x32_bf16 v[32:35], v[112:115], v[96:99], v[32:35]
  ds_read_b128 v[144:147], v13 offset:12288
  ds_read_b128 v[148:151], v13 offset:14336
  v_mfma_f32_16x16x32_bf16 v[36:39], v[112:115], v[100:103], v[36:39]
  v_mfma_f32_16x16x32_bf16 v[40:43], v[112:115], v[104:107], v[40:43]
  v_mfma_f32_16x16x32_bf16 v[44:47], v[112:115], v[108:111], v[44:47]
L_s1Q:
  s_waitcnt lgkmcnt(0)
  v_mfma_f32_16x16x32_bf16 v[16:19], v[152:155], v[120:123], v[16:19]
  s_add_u32 s67, s67, 12288
  s_cmp_eq_u32 s67, 86016
  s_cselect_b32 s67, 0, s67
  v_add_u32 v14, s67, v2
  s_add_u32 s66, s66, 18432
  s_cmp_eq_u32 s66, 73728
  s_cselect_b32 s66, 0, s66
  v_add_u32 v6, s66, v1
  v_add_u32 v13, s66, v3
  v_mfma_f32_16x16x32_bf16 v[20:23], v[152:155], v[124:127], v[20:23]
  s_barrier
  ds_read_b64_tr_b16 v[112:113], v14 offset:0
  ds_read_b64_tr_b16 v[114:115], v14 offset:512
  ds_read_b128 v[80:83], v6 offset:0
  v_mfma_f32_16x16x32_bf16 v[24:27], v[152:155], v[128:131], v[24:27]
  ds_read_b128 v[84:87], v6 offset:2048
  ds_read_b128 v[88:91], v6 offset:4096
  v_mfma_f32_16x16x32_bf16 v[28:31], v[152:155], v[132:135], v[28:31]
  ds_read_b128 v[92:95], v6 offset:6144
  ds_read_b128 v[96:99], v6 offset:8192
  ds_read_b128 v[100:103], v6 offset:10240
  v_mfma_f32_16x16x32_bf16 v[32:35], v[152:155], v[136:139], v[32:35]
  ds_read_b128 v[104:107], v6 offset:12288
  ds_read_b128 v[108:111], v6 offset:14336
  v_mfma_f32_16x16x32_bf16 v[36:39], v[152:155], v[140:143], v[36:39]
  v_mfma_f32_16x16x32_bf16 v[40:43], v[152:155], v[144:147], v[40:43]
  v_mfma_f32_16x16x32_bf16 v[44:47], v[152:155], v[148:151], v[44:47]
  s_add_u32 s61, s61, 1
  s_cmp_lt_u32 s61, 8
  s_cbranch_scc1 L_s0Q
  global_load_dword v160, v15, s[44:45] sc1
  s_waitcnt lgkmcnt(0)
  s_nop 4
  v_pk_fma_f32 v[112:113], v[16:17], v[162:163], v[162:163] op_sel:[0,1,0] op_sel_hi:[1,1,0]
  v_pk_fma_f32 v[114:115], v[18:19], v[162:163], v[162:163] op_sel:[0,1,0] op_sel_hi:[1,1,0]
  v_pk_fma_f32 v[116:117], v[20:21], v[162:163], v[162:163] op_sel:[0,1,0] op_sel_hi:[1,1,0]
  v_pk_fma_f32 v[118:119], v[22:23], v[162:163], v[162:163] op_sel:[0,1,0] op_sel_hi:[1,1,0]
  v_pk_fma_f32 v[120:121], v[24:25], v[162:163], v[162:163] op_sel:[0,1,0] op_sel_hi:[1,1,0]
  v_pk_fma_f32 v[122:123], v[26:27], v[162:163], v[162:163] op_sel:[0,1,0] op_sel_hi:[1,1,0]
  v_pk_fma_f32 v[124:125], v[28:29], v[162:163], v[162:163] op_sel:[0,1,0] op_sel_hi:[1,1,0]
  v_pk_fma_f32 v[126:127], v[30:31], v[162:163], v[162:163] op_sel:[0,1,0] op_sel_hi:[1,1,0]
  v_pk_fma_f32 v[128:129], v[32:33], v[162:163], v[162:163] op_sel:[0,1,0] op_sel_hi:[1,1,0]
  v_pk_fma_f32 v[130:131], v[34:35], v[162:163], v[162:163] op_sel:[0,1,0] op_sel_hi:[1,1,0]
  v_pk_fma_f32 v[132:133], v[36:37], v[162:163], v[162:163] op_sel:[0,1,0] op_sel_hi:[1,1,0]
  v_pk_fma_f32 v[134:135], v[38:39], v[162:163], v[162:163] op_sel:[0,1,0] op_sel_hi:[1,1,0]
  v_pk_fma_f32 v[136:137], v[40:41], v[162:163], v[162:163] op_sel:[0,1,0] op_sel_hi:[1,1,0]
  v_pk_fma_f32 v[138:139], v[42:43], v[162:163], v[162:163] op_sel:[0,1,0] op_sel_hi:[1,1,0]
  v_pk_fma_f32 v[140:141], v[44:45], v[162:163], v[162:163] op_sel:[0,1,0] op_sel_hi:[1,1,0]
  v_pk_fma_f32 v[142:143], v[46:47], v[162:163], v[162:163] op_sel:[0,1,0] op_sel_hi:[1,1,0]
  v_exp_f32 v112, v112 clamp
  v_exp_f32 v113, v113 clamp
  v_exp_f32 v114, v114 clamp
  v_exp_f32 v115, v115 clamp
  v_exp_f32 v116, v116 clamp
  v_exp_f32 v117, v117 clamp
  v_exp_f32 v118, v118 clamp
  v_exp_f32 v119, v119 clamp
  v_exp_f32 v120, v120 clamp
  v_exp_f32 v121, v121 clamp
  v_exp_f32 v122, v122 clamp
  v_exp_f32 v123, v123 clamp
  v_exp_f32 v124, v124 clamp
  v_exp_f32 v125, v125 clamp
  v_exp_f32 v126, v126 clamp
  v_exp_f32 v127, v127 clamp
  v_exp_f32 v128, v128 clamp
  v_exp_f32 v129, v129 clamp
  v_exp_f32 v130, v130 clamp
  v_exp_f32 v131, v131 clamp
  v_exp_f32 v132, v132 clamp
  v_exp_f32 v133, v133 clamp
  v_exp_f32 v134, v134 clamp
  v_exp_f32 v135, v135 clamp
  v_exp_f32 v136, v136 clamp
  v_exp_f32 v137, v137 clamp
  v_exp_f32 v138, v138 clamp
  v_exp_f32 v139, v139 clamp
  v_exp_f32 v140, v140 clamp
  v_exp_f32 v141, v141 clamp
  v_exp_f32 v142, v142 clamp
  v_exp_f32 v143, v143 clamp
  v_max_f32 v16, s68, v16
  v_max_f32 v17, s68, v17
  v_max_f32 v18, s68, v18
  v_max_f32 v19, s68, v19
  v_max_f32 v20, s68, v20
  v_max_f32 v21, s68, v21
  v_max_f32 v22, s68, v22
  v_max_f32 v23, s68, v23
  v_max_f32 v24, s68, v24
  v_max_f32 v25, s68, v25
  v_max_f32 v26, s68, v26
  v_max_f32 v27, s68, v27
  v_max_f32 v28, s68, v28
  v_max_f32 v29, s68, v29
  v_max_f32 v30, s68, v30
  v_max_f32 v31, s68, v31
  v_max_f32 v32, s68, v32
  v_max_f32 v33, s68, v33
  v_max_f32 v34, s68, v34
  v_max_f32 v35, s68, v35
  v_max_f32 v36, s68, v36
  v_max_f32 v37, s68, v37
  v_max_f32 v38, s68, v38
  v_max_f32 v39, s68, v39
  v_max_f32 v40, s68, v40
  v_max_f32 v41, s68, v41
  v_max_f32 v42, s68, v42
  v_max_f32 v43, s68, v43
  v_max_f32 v44, s68, v44
  v_max_f32 v45, s68, v45
  v_max_f32 v46, s68, v46
  v_max_f32 v47, s68, v47
  v_pk_add_f32 v[16:17], v[16:17], v[112:113]
  v_pk_add_f32 v[18:19], v[18:19], v[114:115]
  v_pk_add_f32 v[20:21], v[20:21], v[116:117]
  v_pk_add_f32 v[22:23], v[22:23], v[118:119]
  v_pk_add_f32 v[24:25], v[24:25], v[120:121]
  v_pk_add_f32 v[26:27], v[26:27], v[122:123]
  v_pk_add_f32 v[28:29], v[28:29], v[124:125]
  v_pk_add_f32 v[30:31], v[30:31], v[126:127]
  v_pk_add_f32 v[32:33], v[32:33], v[128:129]
  v_pk_add_f32 v[34:35], v[34:35], v[130:131]
  v_pk_add_f32 v[36:37], v[36:37], v[132:133]
  v_pk_add_f32 v[38:39], v[38:39], v[134:135]
  v_pk_add_f32 v[40:41], v[40:41], v[136:137]
  v_pk_add_f32 v[42:43], v[42:43], v[138:139]
  v_pk_add_f32 v[44:45], v[44:45], v[140:141]
  v_pk_add_f32 v[46:47], v[46:47], v[142:143]
  v_cvt_pk_bf16_f32 v16, v16, v17
  v_cvt_pk_bf16_f32 v17, v18, v19
  v_cvt_pk_bf16_f32 v18, v20, v21
  v_cvt_pk_bf16_f32 v19, v22, v23
  v_cvt_pk_bf16_f32 v20, v24, v25
  v_cvt_pk_bf16_f32 v21, v26, v27
  v_cvt_pk_bf16_f32 v22, v28, v29
  v_cvt_pk_bf16_f32 v23, v30, v31
  v_cvt_pk_bf16_f32 v24, v32, v33
  v_cvt_pk_bf16_f32 v25, v34, v35
  v_cvt_pk_bf16_f32 v26, v36, v37
  v_cvt_pk_bf16_f32 v27, v38, v39
  v_cvt_pk_bf16_f32 v28, v40, v41
  v_cvt_pk_bf16_f32 v29, v42, v43
  v_cvt_pk_bf16_f32 v30, v44, v45
  v_cvt_pk_bf16_f32 v31, v46, v47
  s_nop 1
  v_permlane16_swap_b32 v16, v18
  v_permlane16_swap_b32 v17, v19
  v_permlane16_swap_b32 v20, v22
  v_permlane16_swap_b32 v21, v23
  v_permlane16_swap_b32 v24, v26
  v_permlane16_swap_b32 v25, v27
  v_permlane16_swap_b32 v28, v30
  v_permlane16_swap_b32 v29, v31
  s_add_u32 s57, s72, 0
  buffer_store_dwordx4 v[16:19], v5, s[40:43], s57 offen sc1
  s_add_u32 s57, s72, 32768
  buffer_store_dwordx4 v[20:23], v5, s[40:43], s57 offen sc1
  s_add_u32 s57, s72, 65536
  buffer_store_dwordx4 v[24:27], v5, s[40:43], s57 offen sc1
  s_add_u32 s57, s72, 98304
  buffer_store_dwordx4 v[28:31], v5, s[40:43], s57 offen sc1
L_phase2:
  s_lshr_b32 s59, s54, 1
  s_cmp_eq_u32 s59, 0
  s_mov_b32 s12, 98304
  s_cselect_b32 s12, 2048, s12
  s_mov_b32 s13, 20480
  s_cselect_b32 s13, 114688, s13
  s_mov_b32 s14, 38912
  s_cselect_b32 s14, 131072, s14
  s_mov_b32 s15, 73728
  s_cselect_b32 s15, 57344, s15
  s_add_u32 s57, s50, 0
  s_and_b32 s57, s57, 3
  s_lshl_b32 s4, s57, 12
  s_add_u32 s57, s50, 1
  s_and_b32 s57, s57, 3
  s_lshl_b32 s5, s57, 12
  s_add_u32 s57, s50, 2
  s_and_b32 s57, s57, 3
  s_lshl_b32 s6, s57, 12
  s_add_u32 s57, s50, 3
  s_and_b32 s57, s57, 3
  s_lshl_b32 s7, s57, 12
  v_and_b32 v11, 15, v0
  v_lshrrev_b32 v12, 4, v0
  v_lshrrev_b32 v13, 2, v11
  v_lshl_add_u32 v13, v12, 3, v13
  v_and_b32 v14, 3, v11
  v_lshlrev_b32 v14, 4, v14
  v_lshl_add_u32 v14, v13, 7, v14
  v_bfe_u32 v10, v13, 1, 1
  s_and_b32 s57, s54, 1
  v_xor_b32 v10, s57, v10
  v_lshl_add_u32 v6, v10, 6, v14
  v_add_u32 v2, s12, v6
  v_add_u32 v3, s13, v6
  v_lshlrev_b32 v11, 12, v11
  v_lshl_add_u32 v1, v12, 4, v11
  s_lshl_b32 s70, s49, 17
  s_lshl_b32 s57, s55, 16
  s_add_u32 s70, s70, s57
  s_lshl_b32 s57, s46, 10
  s_add_u32 s70, s70, s57
  s_lshl_b32 s57, s50, 8
  s_add_u32 s70, s70, s57
  s_lshl_b32 s57, s54, 6
  s_add_u32 s70, s70, s57
  s_mul_i32 s71, s55, 98304
  s_cmp_eq_u32 s61, 99
  s_cbranch_scc1 L_idP
  s_mov_b32 s58, 0x01010101
L_icP:
  s_waitcnt vmcnt(0)
  v_cmp_ne_u32 vcc, s58, v160
  s_nop 3
  s_cmp_eq_u64 vcc, 0
  s_cbranch_scc1 L_idP
  s_add_u32 s73, s73, 1
  s_cmp_gt_u32 s73, 0x40000
  s_cbranch_scc1 L_idP
  s_sleep 4
  global_load_dword v160, v15, s[44:45] sc1
  s_branch L_icP
L_idP:
  s_barrier
  s_barrier
  ds_read_b64_tr_b16 v[104:105], v2 offset:0
  ds_read_b64_tr_b16 v[106:107], v2 offset:512
  ds_read_b64_tr_b16 v[108:109], v2 offset:8
  ds_read_b64_tr_b16 v[110:111], v2 offset:520
  ds_read_b64_tr_b16 v[112:113], v2 offset:4096
  ds_read_b64_tr_b16 v[114:115], v2 offset:4608
  ds_read_b64_tr_b16 v[116:117], v2 offset:4104
  ds_read_b64_tr_b16 v[118:119], v2 offset:4616
  ds_read_b64_tr_b16 v[120:121], v2 offset:8192
  ds_read_b64_tr_b16 v[122:123], v2 offset:8704
  ds_read_b64_tr_b16 v[124:125], v2 offset:8200
  ds_read_b64_tr_b16 v[126:127], v2 offset:8712
  ds_read_b64_tr_b16 v[128:129], v2 offset:12288
  ds_read_b64_tr_b16 v[130:131], v2 offset:12800
  ds_read_b64_tr_b16 v[132:133], v2 offset:12296
  ds_read_b64_tr_b16 v[134:135], v2 offset:12808
  ds_read_b64_tr_b16 v[136:137], v3 offset:0
  ds_read_b64_tr_b16 v[138:139], v3 offset:512
  ds_read_b64_tr_b16 v[140:141], v3 offset:8
  ds_read_b64_tr_b16 v[142:143], v3 offset:520
  ds_read_b64_tr_b16 v[144:145], v3 offset:4096
  ds_read_b64_tr_b16 v[146:147], v3 offset:4608
  ds_read_b64_tr_b16 v[148:149], v3 offset:4104
  ds_read_b64_tr_b16 v[150:151], v3 offset:4616
  ds_read_b64_tr_b16 v[152:153], v3 offset:8192
  ds_read_b64_tr_b16 v[154:155], v3 offset:8704
  ds_read_b64_tr_b16 v[156:157], v3 offset:8200
  ds_read_b64_tr_b16 v[158:159], v3 offset:8712
  ds_read_b64_tr_b16 v[160:161], v3 offset:12288
  ds_read_b64_tr_b16 v[162:163], v3 offset:12800
  ds_read_b64_tr_b16 v[164:165], v3 offset:12296
  ds_read_b64_tr_b16 v[166:167], v3 offset:12808
  v_lshlrev_b32 v5, 4, v0
  v_add_u32 v5, s71, v5
  v_and_b32 v11, 31, v0
  v_lshrrev_b32 v12, 5, v0
  v_lshrrev_b32 v13, 4, v11
  v_lshlrev_b32 v13, 14, v13
  v_lshl_add_u32 v13, v12, 8, v13
  v_and_b32 v14, 15, v11
  v_lshl_add_u32 v7, v14, 4, v13
  v_lshlrev_b32 v13, 4, v14
  v_lshl_add_u32 v13, v12, 8, v13
  v_lshlrev_b32 v10, 4, v12
  v_add_u32 v10, 512, v10
  v_cmp_lt_u32 vcc, 15, v11
  s_nop 1
  v_cndmask_b32 v4, v13, v10, vcc
  s_lshl_b32 s69, s49, 16
  s_add_u32 s69, s69, 0x200000
  s_mov_b32 s68, 0x358637bd
  s_waitcnt lgkmcnt(0)
  s_barrier
  v_add_u32 v2, s14, v6
  v_add_u32 v3, s15, v6
  v_add_u32 v8, s4, v5
  v_add_u32 v9, s5, v5
  v_add_u32 v10, s6, v5
  v_add_u32 v11, s7, v5
  s_cmp_lg_u32 s46, 0
  s_cbranch_scc1 L_p2B
  s_barrier
  ds_read_b128 v[40:43], v8 offset:0
  ds_read_b128 v[44:47], v8 offset:16384
  ds_read_b128 v[48:51], v8 offset:1024
  ds_read_b128 v[52:55], v8 offset:17408
  ds_read_b128 v[56:59], v8 offset:2048
  ds_read_b128 v[60:63], v8 offset:18432
  ds_read_b128 v[64:67], v8 offset:3072
  ds_read_b128 v[68:71], v8 offset:19456
  s_waitcnt lgkmcnt(6)
  v_mfma_f32_16x16x32_bf16 v[16:19], v[104:107], v[40:43], 0
  v_mfma_f32_16x16x32_bf16 v[20:23], v[108:111], v[40:43], 0
  v_mfma_f32_16x16x32_bf16 v[24:27], v[104:107], v[44:47], 0
  v_mfma_f32_16x16x32_bf16 v[28:31], v[108:111], v[44:47], 0
  ds_read_b64_tr_b16 v[104:105], v2 offset:0
  ds_read_b64_tr_b16 v[106:107], v2 offset:512
  ds_read_b64_tr_b16 v[108:109], v2 offset:8
  ds_read_b64_tr_b16 v[110:111], v2 offset:520
  s_waitcnt lgkmcnt(8)
  v_mfma_f32_16x16x32_bf16 v[16:19], v[112:115], v[48:51], v[16:19]
  v_mfma_f32_16x16x32_bf16 v[20:23], v[116:119], v[48:51], v[20:23]
  s_barrier
  ds_read_b128 v[72:75], v9 offset:0
  ds_read_b128 v[76:79], v9 offset:16384
  ds_read_b128 v[80:83], v9 offset:1024
  ds_read_b128 v[84:87], v9 offset:17408
  v_mfma_f32_16x16x32_bf16 v[24:27], v[112:115], v[52:55], v[24:27]
  v_mfma_f32_16x16x32_bf16 v[28:31], v[116:119], v[52:55], v[28:31]
  ds_read_b64_tr_b16 v[112:113], v2 offset:4096
  ds_read_b64_tr_b16 v[114:115], v2 offset:4608
  ds_read_b64_tr_b16 v[116:117], v2 offset:4104
  ds_read_b64_tr_b16 v[118:119], v2 offset:4616
  s_waitcnt lgkmcnt(14)
  v_mfma_f32_16x16x32_bf16 v[16:19], v[120:123], v[56:59], v[16:19]
  v_mfma_f32_16x16x32_bf16 v[20:23], v[124:127], v[56:59], v[20:23]
  ds_read_b128 v[88:91], v9 offset:2048
  ds_read_b128 v[92:95], v9 offset:18432
  ds_read_b128 v[96:99], v9 offset:3072
  ds_read_b128 v[100:103], v9 offset:19456
  v_mfma_f32_16x16x32_bf16 v[24:27], v[120:123], v[60:63], v[24:27]
  v_mfma_f32_16x16x32_bf16 v[28:31], v[124:127], v[60:63], v[28:31]
  ds_read_b64_tr_b16 v[120:121], v2 offset:8192
  ds_read_b64_tr_b16 v[122:123], v2 offset:8704
  ds_read_b64_tr_b16 v[124:125], v2 offset:8200
  ds_read_b64_tr_b16 v[126:127], v2 offset:8712
  s_waitcnt lgkmcnt(15)
  v_mfma_f32_16x16x32_bf16 v[16:19], v[128:131], v[64:67], v[16:19]
  v_mfma_f32_16x16x32_bf16 v[20:23], v[132:135], v[64:67], v[20:23]
  v_mfma_f32_16x16x32_bf16 v[24:27], v[128:131], v[68:71], v[24:27]
  v_mfma_f32_16x16x32_bf16 v[28:31], v[132:135], v[68:71], v[28:31]
  ds_read_b64_tr_b16 v[128:129], v2 offset:12288
  ds_read_b64_tr_b16 v[130:131], v2 offset:12800
  ds_read_b64_tr_b16 v[132:133], v2 offset:12296
  ds_read_b64_tr_b16 v[134:135], v2 offset:12808
  s_waitcnt lgkmcnt(15)
  v_mfma_f32_16x16x32_bf16 v[16:19], v[136:139], v[72:75], v[16:19]
  v_mfma_f32_16x16x32_bf16 v[20:23], v[140:143], v[72:75], v[20:23]
  v_mfma_f32_16x16x32_bf16 v[24:27], v[136:139], v[76:79], v[24:27]
  v_mfma_f32_16x16x32_bf16 v[28:31], v[140:143], v[76:79], v[28:31]
  ds_read_b64_tr_b16 v[136:137], v3 offset:0
  ds_read_b64_tr_b16 v[138:139], v3 offset:512
  ds_read_b64_tr_b16 v[140:141], v3 offset:8
  ds_read_b64_tr_b16 v[142:143], v3 offset:520
  s_waitcnt lgkmcnt(15)
  v_mfma_f32_16x16x32_bf16 v[16:19], v[144:147], v[80:83], v[16:19]
  v_mfma_f32_16x16x32_bf16 v[20:23], v[148:151], v[80:83], v[20:23]
  s_barrier
  ds_read_b128 v[40:43], v10 offset:0
  ds_read_b128 v[44:47], v10 offset:16384
  ds_read_b128 v[48:51], v10 offset:1024
  ds_read_b128 v[52:55], v10 offset:17408
  v_mfma_f32_16x16x32_bf16 v[24:27], v[144:147], v[84:87], v[24:27]
  v_mfma_f32_16x16x32_bf16 v[28:31], v[148:151], v[84:87], v[28:31]
  ds_read_b64_tr_b16 v[144:145], v3 offset:4096
  ds_read_b64_tr_b16 v[146:147], v3 offset:4608
  ds_read_b64_tr_b16 v[148:149], v3 offset:4104
  ds_read_b64_tr_b16 v[150:151], v3 offset:4616
  s_waitcnt lgkmcnt(15)
  v_mfma_f32_16x16x32_bf16 v[16:19], v[152:155], v[88:91], v[16:19]
  v_mfma_f32_16x16x32_bf16 v[20:23], v[156:159], v[88:91], v[20:23]
  ds_read_b128 v[56:59], v10 offset:2048
  ds_read_b128 v[60:63], v10 offset:18432
  ds_read_b128 v[64:67], v10 offset:3072
  ds_read_b128 v[68:71], v10 offset:19456
  v_mfma_f32_16x16x32_bf16 v[24:27], v[152:155], v[92:95], v[24:27]
  v_mfma_f32_16x16x32_bf16 v[28:31], v[156:159], v[92:95], v[28:31]
  ds_read_b64_tr_b16 v[152:153], v3 offset:8192
  ds_read_b64_tr_b16 v[154:155], v3 offset:8704
  ds_read_b64_tr_b16 v[156:157], v3 offset:8200
  ds_read_b64_tr_b16 v[158:159], v3 offset:8712
  s_waitcnt lgkmcnt(15)
  v_mfma_f32_16x16x32_bf16 v[16:19], v[160:163], v[96:99], v[16:19]
  v_mfma_f32_16x16x32_bf16 v[20:23], v[164:167], v[96:99], v[20:23]
  v_mfma_f32_16x16x32_bf16 v[24:27], v[160:163], v[100:103], v[24:27]
  v_mfma_f32_16x16x32_bf16 v[28:31], v[164:167], v[100:103], v[28:31]
  ds_read_b64_tr_b16 v[160:161], v3 offset:12288
  ds_read_b64_tr_b16 v[162:163], v3 offset:12800
  ds_read_b64_tr_b16 v[164:165], v3 offset:12296
  ds_read_b64_tr_b16 v[166:167], v3 offset:12808
  s_waitcnt lgkmcnt(15)
  v_mfma_f32_16x16x32_bf16 v[16:19], v[104:107], v[40:43], v[16:19]
  v_mfma_f32_16x16x32_bf16 v[20:23], v[108:111], v[40:43], v[20:23]
  v_mfma_f32_16x16x32_bf16 v[24:27], v[104:107], v[44:47], v[24:27]
  v_mfma_f32_16x16x32_bf16 v[28:31], v[108:111], v[44:47], v[28:31]
  s_waitcnt lgkmcnt(15)
  v_mfma_f32_16x16x32_bf16 v[16:19], v[112:115], v[48:51], v[16:19]
  v_mfma_f32_16x16x32_bf16 v[20:23], v[116:119], v[48:51], v[20:23]
  s_barrier
  ds_read_b128 v[72:75], v11 offset:0
  ds_read_b128 v[76:79], v11 offset:16384
  ds_read_b128 v[80:83], v11 offset:1024
  ds_read_b128 v[84:87], v11 offset:17408
  v_mfma_f32_16x16x32_bf16 v[24:27], v[112:115], v[52:55], v[24:27]
  v_mfma_f32_16x16x32_bf16 v[28:31], v[116:119], v[52:55], v[28:31]
  s_waitcnt lgkmcnt(14)
  v_mfma_f32_16x16x32_bf16 v[16:19], v[120:123], v[56:59], v[16:19]
  v_mfma_f32_16x16x32_bf16 v[20:23], v[124:127], v[56:59], v[20:23]
  ds_read_b128 v[88:91], v11 offset:2048
  ds_read_b128 v[92:95], v11 offset:18432
  ds_read_b128 v[96:99], v11 offset:3072
  ds_read_b128 v[100:103], v11 offset:19456
  v_mfma_f32_16x16x32_bf16 v[24:27], v[120:123], v[60:63], v[24:27]
  v_mfma_f32_16x16x32_bf16 v[28:31], v[124:127], v[60:63], v[28:31]
  s_waitcnt lgkmcnt(15)
  v_mfma_f32_16x16x32_bf16 v[16:19], v[128:131], v[64:67], v[16:19]
  v_mfma_f32_16x16x32_bf16 v[20:23], v[132:135], v[64:67], v[20:23]
  v_mfma_f32_16x16x32_bf16 v[24:27], v[128:131], v[68:71], v[24:27]
  v_mfma_f32_16x16x32_bf16 v[28:31], v[132:135], v[68:71], v[28:31]
  s_waitcnt lgkmcnt(6)
  v_mfma_f32_16x16x32_bf16 v[16:19], v[136:139], v[72:75], v[16:19]
  v_mfma_f32_16x16x32_bf16 v[20:23], v[140:143], v[72:75], v[20:23]
  v_mfma_f32_16x16x32_bf16 v[24:27], v[136:139], v[76:79], v[24:27]
  v_mfma_f32_16x16x32_bf16 v[28:31], v[140:143], v[76:79], v[28:31]
  s_waitcnt lgkmcnt(4)
  v_mfma_f32_16x16x32_bf16 v[16:19], v[144:147], v[80:83], v[16:19]
  v_mfma_f32_16x16x32_bf16 v[20:23], v[148:151], v[80:83], v[20:23]
  v_mfma_f32_16x16x32_bf16 v[24:27], v[144:147], v[84:87], v[24:27]
  v_mfma_f32_16x16x32_bf16 v[28:31], v[148:151], v[84:87], v[28:31]
  s_waitcnt lgkmcnt(2)
  v_mfma_f32_16x16x32_bf16 v[16:19], v[152:155], v[88:91], v[16:19]
  v_mfma_f32_16x16x32_bf16 v[20:23], v[156:159], v[88:91], v[20:23]
  v_mfma_f32_16x16x32_bf16 v[24:27], v[152:155], v[92:95], v[24:27]
  v_mfma_f32_16x16x32_bf16 v[28:31], v[156:159], v[92:95], v[28:31]
  s_waitcnt lgkmcnt(0)
  v_mfma_f32_16x16x32_bf16 v[16:19], v[160:163], v[96:99], v[16:19]
  v_mfma_f32_16x16x32_bf16 v[20:23], v[164:167], v[96:99], v[20:23]
  v_mfma_f32_16x16x32_bf16 v[24:27], v[160:163], v[100:103], v[24:27]
  v_mfma_f32_16x16x32_bf16 v[28:31], v[164:167], v[100:103], v[28:31]
  s_branch L_fin
L_p2B:
  s_lshr_b32 s16, s51, 1
  s_lshl_b32 s16, s16, 10
  s_and_b32 s57, s51, 1
  s_lshl_b32 s57, s57, 9
  s_add_u32 s16, s16, s57
  s_lshr_b32 s57, s4, 9
  s_add_u32 s57, s57, s51
  s_mul_i32 s58, s57, 544
  s_cmp_lt_u32 s57, 11
  s_cselect_b32 s57, 0, 108704
  s_add_u32 s58, s58, s57
  s_add_u32 s58, s58, 32768
  v_add_u32 v12, s58, v4
  s_lshr_b32 s57, s5, 9
  s_add_u32 s57, s57, s51
  s_mul_i32 s58, s57, 544
  s_cmp_lt_u32 s57, 11
  s_cselect_b32 s57, 0, 108704
  s_add_u32 s58, s58, s57
  s_add_u32 s58, s58, 32768
  v_add_u32 v13, s58, v4
  s_lshr_b32 s57, s6, 9
  s_add_u32 s57, s57, s51
  s_mul_i32 s58, s57, 544
  s_cmp_lt_u32 s57, 11
  s_cselect_b32 s57, 0, 108704
  s_add_u32 s58, s58, s57
  s_add_u32 s58, s58, 32768
  v_add_u32 v14, s58, v4
  s_lshr_b32 s57, s7, 9
  s_add_u32 s57, s57, s51
  s_mul_i32 s58, s57, 544
  s_cmp_lt_u32 s57, 11
  s_cselect_b32 s57, 0, 108704
  s_add_u32 s58, s58, s57
  s_add_u32 s58, s58, 32768
  v_add_u32 v15, s58, v4
  s_barrier
  s_add_u32 s59, s16, s4
  s_add_u32 s59, s59, s69
  s_add_u32 s60, s59, 32768
  buffer_load_dwordx4 v[40:43], v7, s[40:43], s59 offen
  buffer_load_dwordx4 v[44:47], v7, s[40:43], s60 offen
  s_add_u32 s59, s16, s5
  s_add_u32 s59, s59, s69
  s_add_u32 s60, s59, 32768
  buffer_load_dwordx4 v[48:51], v7, s[40:43], s59 offen
  buffer_load_dwordx4 v[52:55], v7, s[40:43], s60 offen
  s_add_u32 s59, s16, s6
  s_add_u32 s59, s59, s69
  s_add_u32 s60, s59, 32768
  buffer_load_dwordx4 v[56:59], v7, s[40:43], s59 offen
  buffer_load_dwordx4 v[60:63], v7, s[40:43], s60 offen
  s_add_u32 s59, s16, s7
  s_add_u32 s59, s59, s69
  s_add_u32 s60, s59, 32768
  buffer_load_dwordx4 v[64:67], v7, s[40:43], s59 offen
  buffer_load_dwordx4 v[68:71], v7, s[40:43], s60 offen
  v_add_u32 v32, s16, v7
  v_add_u32 v33, 98304, v32
  s_barrier
  ds_read_b128 v[16:19], v12
  ds_read_b128 v[20:23], v13
  ds_read_b128 v[24:27], v14
  ds_read_b128 v[28:31], v15
  s_waitcnt lgkmcnt(0)
  s_waitcnt vmcnt(7)
  v_mfma_f32_32x32x16_bf16 v[72:87], v[16:19], v[40:43], 0
  s_waitcnt vmcnt(6)
  v_mfma_f32_32x32x16_bf16 v[88:103], v[16:19], v[44:47], 0
  s_nop 10
  v_add_f32 v80, s68, v80
  v_rcp_f32 v80, v80
  v_add_u32 v34, s4, v32
  v_pk_mul_f32 v[72:73], v[72:73], v[80:81] op_sel_hi:[1,0]
  v_pk_mul_f32 v[74:75], v[74:75], v[80:81] op_sel_hi:[1,0]
  v_pk_mul_f32 v[76:77], v[76:77], v[80:81] op_sel_hi:[1,0]
  v_pk_mul_f32 v[78:79], v[78:79], v[80:81] op_sel_hi:[1,0]
  v_cvt_pk_bf16_f32 v40, v72, v73
  v_cvt_pk_bf16_f32 v41, v74, v75
  v_cvt_pk_bf16_f32 v42, v76, v77
  v_cvt_pk_bf16_f32 v43, v78, v79
  ds_write_b128 v34, v[40:43]
  s_waitcnt vmcnt(5)
  v_mfma_f32_32x32x16_bf16 v[72:87], v[20:23], v[48:51], 0
  v_add_f32 v96, s68, v96
  v_rcp_f32 v96, v96
  v_add_u32 v35, s4, v33
  v_pk_mul_f32 v[88:89], v[88:89], v[96:97] op_sel_hi:[1,0]
  v_pk_mul_f32 v[90:91], v[90:91], v[96:97] op_sel_hi:[1,0]
  v_pk_mul_f32 v[92:93], v[92:93], v[96:97] op_sel_hi:[1,0]
  v_pk_mul_f32 v[94:95], v[94:95], v[96:97] op_sel_hi:[1,0]
  v_cvt_pk_bf16_f32 v44, v88, v89
  v_cvt_pk_bf16_f32 v45, v90, v91
  v_cvt_pk_bf16_f32 v46, v92, v93
  v_cvt_pk_bf16_f32 v47, v94, v95
  ds_write_b128 v35, v[44:47]
  s_waitcnt vmcnt(4)
  v_mfma_f32_32x32x16_bf16 v[88:103], v[20:23], v[52:55], 0
  v_add_f32 v80, s68, v80
  v_rcp_f32 v80, v80
  v_add_u32 v34, s5, v32
  v_pk_mul_f32 v[72:73], v[72:73], v[80:81] op_sel_hi:[1,0]
  v_pk_mul_f32 v[74:75], v[74:75], v[80:81] op_sel_hi:[1,0]
  v_pk_mul_f32 v[76:77], v[76:77], v[80:81] op_sel_hi:[1,0]
  v_pk_mul_f32 v[78:79], v[78:79], v[80:81] op_sel_hi:[1,0]
  v_cvt_pk_bf16_f32 v48, v72, v73
  v_cvt_pk_bf16_f32 v49, v74, v75
  v_cvt_pk_bf16_f32 v50, v76, v77
  v_cvt_pk_bf16_f32 v51, v78, v79
  ds_write_b128 v34, v[48:51]
  s_waitcnt vmcnt(3)
  v_mfma_f32_32x32x16_bf16 v[72:87], v[24:27], v[56:59], 0
  v_add_f32 v96, s68, v96
  v_rcp_f32 v96, v96
  v_add_u32 v35, s5, v33
  v_pk_mul_f32 v[88:89], v[88:89], v[96:97] op_sel_hi:[1,0]
  v_pk_mul_f32 v[90:91], v[90:91], v[96:97] op_sel_hi:[1,0]
  v_pk_mul_f32 v[92:93], v[92:93], v[96:97] op_sel_hi:[1,0]
  v_pk_mul_f32 v[94:95], v[94:95], v[96:97] op_sel_hi:[1,0]
  v_cvt_pk_bf16_f32 v52, v88, v89
  v_cvt_pk_bf16_f32 v53, v90, v91
  v_cvt_pk_bf16_f32 v54, v92, v93
  v_cvt_pk_bf16_f32 v55, v94, v95
  ds_write_b128 v35, v[52:55]
  s_waitcnt vmcnt(2)
  v_mfma_f32_32x32x16_bf16 v[88:103], v[24:27], v[60:63], 0
  v_add_f32 v80, s68, v80
  v_rcp_f32 v80, v80
  v_add_u32 v34, s6, v32
  v_pk_mul_f32 v[72:73], v[72:73], v[80:81] op_sel_hi:[1,0]
  v_pk_mul_f32 v[74:75], v[74:75], v[80:81] op_sel_hi:[1,0]
  v_pk_mul_f32 v[76:77], v[76:77], v[80:81] op_sel_hi:[1,0]
  v_pk_mul_f32 v[78:79], v[78:79], v[80:81] op_sel_hi:[1,0]
  v_cvt_pk_bf16_f32 v56, v72, v73
  v_cvt_pk_bf16_f32 v57, v74, v75
  v_cvt_pk_bf16_f32 v58, v76, v77
  v_cvt_pk_bf16_f32 v59, v78, v79
  ds_write_b128 v34, v[56:59]
  s_waitcnt vmcnt(1)
  v_mfma_f32_32x32x16_bf16 v[72:87], v[28:31], v[64:67], 0
  v_add_f32 v96, s68, v96
  v_rcp_f32 v96, v96
  v_add_u32 v35, s6, v33
  v_pk_mul_f32 v[88:89], v[88:89], v[96:97] op_sel_hi:[1,0]
  v_pk_mul_f32 v[90:91], v[90:91], v[96:97] op_sel_hi:[1,0]
  v_pk_mul_f32 v[92:93], v[92:93], v[96:97] op_sel_hi:[1,0]
  v_pk_mul_f32 v[94:95], v[94:95], v[96:97] op_sel_hi:[1,0]
  v_cvt_pk_bf16_f32 v60, v88, v89
  v_cvt_pk_bf16_f32 v61, v90, v91
  v_cvt_pk_bf16_f32 v62, v92, v93
  v_cvt_pk_bf16_f32 v63, v94, v95
  ds_write_b128 v35, v[60:63]
  s_waitcnt vmcnt(0)
  v_mfma_f32_32x32x16_bf16 v[88:103], v[28:31], v[68:71], 0
  v_add_f32 v80, s68, v80
  v_rcp_f32 v80, v80
  v_add_u32 v34, s7, v32
  v_pk_mul_f32 v[72:73], v[72:73], v[80:81] op_sel_hi:[1,0]
  v_pk_mul_f32 v[74:75], v[74:75], v[80:81] op_sel_hi:[1,0]
  v_pk_mul_f32 v[76:77], v[76:77], v[80:81] op_sel_hi:[1,0]
  v_pk_mul_f32 v[78:79], v[78:79], v[80:81] op_sel_hi:[1,0]
  v_cvt_pk_bf16_f32 v64, v72, v73
  v_cvt_pk_bf16_f32 v65, v74, v75
  v_cvt_pk_bf16_f32 v66, v76, v77
  v_cvt_pk_bf16_f32 v67, v78, v79
  ds_write_b128 v34, v[64:67]
  s_nop 0
  v_add_f32 v96, s68, v96
  v_rcp_f32 v96, v96
  v_add_u32 v35, s7, v33
  v_pk_mul_f32 v[88:89], v[88:89], v[96:97] op_sel_hi:[1,0]
  v_pk_mul_f32 v[90:91], v[90:91], v[96:97] op_sel_hi:[1,0]
  v_pk_mul_f32 v[92:93], v[92:93], v[96:97] op_sel_hi:[1,0]
  v_pk_mul_f32 v[94:95], v[94:95], v[96:97] op_sel_hi:[1,0]
  v_cvt_pk_bf16_f32 v68, v88, v89
  v_cvt_pk_bf16_f32 v69, v90, v91
  v_cvt_pk_bf16_f32 v70, v92, v93
  v_cvt_pk_bf16_f32 v71, v94, v95
  ds_write_b128 v35, v[68:71]
  s_waitcnt lgkmcnt(0)
  s_barrier
  ds_read_b128 v[40:43], v8 offset:0
  ds_read_b128 v[44:47], v8 offset:16384
  ds_read_b128 v[48:51], v8 offset:1024
  ds_read_b128 v[52:55], v8 offset:17408
  ds_read_b128 v[56:59], v8 offset:2048
  ds_read_b128 v[60:63], v8 offset:18432
  ds_read_b128 v[64:67], v8 offset:3072
  ds_read_b128 v[68:71], v8 offset:19456
  s_waitcnt lgkmcnt(6)
  v_mfma_f32_16x16x32_bf16 v[16:19], v[104:107], v[40:43], 0
  v_mfma_f32_16x16x32_bf16 v[20:23], v[108:111], v[40:43], 0
  ds_read_b128 v[72:75], v9 offset:0
  ds_read_b128 v[76:79], v9 offset:16384
  v_mfma_f32_16x16x32_bf16 v[24:27], v[104:107], v[44:47], 0
  v_mfma_f32_16x16x32_bf16 v[28:31], v[108:111], v[44:47], 0
  ds_read_b64_tr_b16 v[104:105], v2 offset:0
  ds_read_b64_tr_b16 v[106:107], v2 offset:512
  ds_read_b64_tr_b16 v[108:109], v2 offset:8
  ds_read_b64_tr_b16 v[110:111], v2 offset:520
  s_waitcnt lgkmcnt(10)
  v_mfma_f32_16x16x32_bf16 v[16:19], v[112:115], v[48:51], v[16:19]
  v_mfma_f32_16x16x32_bf16 v[20:23], v[116:119], v[48:51], v[20:23]
  ds_read_b128 v[80:83], v9 offset:1024
  ds_read_b128 v[84:87], v9 offset:17408
  v_mfma_f32_16x16x32_bf16 v[24:27], v[112:115], v[52:55], v[24:27]
  v_mfma_f32_16x16x32_bf16 v[28:31], v[116:119], v[52:55], v[28:31]
  ds_read_b64_tr_b16 v[112:113], v2 offset:4096
  ds_read_b64_tr_b16 v[114:115], v2 offset:4608
  ds_read_b64_tr_b16 v[116:117], v2 offset:4104
  ds_read_b64_tr_b16 v[118:119], v2 offset:4616
  s_waitcnt lgkmcnt(14)
  v_mfma_f32_16x16x32_bf16 v[16:19], v[120:123], v[56:59], v[16:19]
  v_mfma_f32_16x16x32_bf16 v[20:23], v[124:127], v[56:59], v[20:23]
  ds_read_b128 v[88:91], v9 offset:2048
  ds_read_b128 v[92:95], v9 offset:18432
  v_mfma_f32_16x16x32_bf16 v[24:27], v[120:123], v[60:63], v[24:27]
  v_mfma_f32_16x16x32_bf16 v[28:31], v[124:127], v[60:63], v[28:31]
  ds_read_b64_tr_b16 v[120:121], v2 offset:8192
  ds_read_b64_tr_b16 v[122:123], v2 offset:8704
  ds_read_b64_tr_b16 v[124:125], v2 offset:8200
  ds_read_b64_tr_b16 v[126:127], v2 offset:8712
  s_waitcnt lgkmcnt(15)
  v_mfma_f32_16x16x32_bf16 v[16:19], v[128:131], v[64:67], v[16:19]
  v_mfma_f32_16x16x32_bf16 v[20:23], v[132:135], v[64:67], v[20:23]
  ds_read_b128 v[96:99], v9 offset:3072
  ds_read_b128 v[100:103], v9 offset:19456
  v_mfma_f32_16x16x32_bf16 v[24:27], v[128:131], v[68:71], v[24:27]
  v_mfma_f32_16x16x32_bf16 v[28:31], v[132:135], v[68:71], v[28:31]
  ds_read_b64_tr_b16 v[128:129], v2 offset:12288
  ds_read_b64_tr_b16 v[130:131], v2 offset:12800
  ds_read_b64_tr_b16 v[132:133], v2 offset:12296
  ds_read_b64_tr_b16 v[134:135], v2 offset:12808
  s_waitcnt lgkmcnt(15)
  v_mfma_f32_16x16x32_bf16 v[16:19], v[136:139], v[72:75], v[16:19]
  v_mfma_f32_16x16x32_bf16 v[20:23], v[140:143], v[72:75], v[20:23]
  ds_read_b128 v[40:43], v10 offset:0
  ds_read_b128 v[44:47], v10 offset:16384
  v_mfma_f32_16x16x32_bf16 v[24:27], v[136:139], v[76:79], v[24:27]
  v_mfma_f32_16x16x32_bf16 v[28:31], v[140:143], v[76:79], v[28:31]
  ds_read_b64_tr_b16 v[136:137], v3 offset:0
  ds_read_b64_tr_b16 v[138:139], v3 offset:512
  ds_read_b64_tr_b16 v[140:141], v3 offset:8
  ds_read_b64_tr_b16 v[142:143], v3 offset:520
  s_waitcnt lgkmcnt(15)
  v_mfma_f32_16x16x32_bf16 v[16:19], v[144:147], v[80:83], v[16:19]
  v_mfma_f32_16x16x32_bf16 v[20:23], v[148:151], v[80:83], v[20:23]
  ds_read_b128 v[48:51], v10 offset:1024
  ds_read_b128 v[52:55], v10 offset:17408
  v_mfma_f32_16x16x32_bf16 v[24:27], v[144:147], v[84:87], v[24:27]
  v_mfma_f32_16x16x32_bf16 v[28:31], v[148:151], v[84:87], v[28:31]
  ds_read_b64_tr_b16 v[144:145], v3 offset:4096
  ds_read_b64_tr_b16 v[146:147], v3 offset:4608
  ds_read_b64_tr_b16 v[148:149], v3 offset:4104
  ds_read_b64_tr_b16 v[150:151], v3 offset:4616
  s_waitcnt lgkmcnt(15)
  v_mfma_f32_16x16x32_bf16 v[16:19], v[152:155], v[88:91], v[16:19]
  v_mfma_f32_16x16x32_bf16 v[20:23], v[156:159], v[88:91], v[20:23]
  ds_read_b128 v[56:59], v10 offset:2048
  ds_read_b128 v[60:63], v10 offset:18432
  v_mfma_f32_16x16x32_bf16 v[24:27], v[152:155], v[92:95], v[24:27]
  v_mfma_f32_16x16x32_bf16 v[28:31], v[156:159], v[92:95], v[28:31]
  ds_read_b64_tr_b16 v[152:153], v3 offset:8192
  ds_read_b64_tr_b16 v[154:155], v3 offset:8704
  ds_read_b64_tr_b16 v[156:157], v3 offset:8200
  ds_read_b64_tr_b16 v[158:159], v3 offset:8712
  s_waitcnt lgkmcnt(15)
  v_mfma_f32_16x16x32_bf16 v[16:19], v[160:163], v[96:99], v[16:19]
  v_mfma_f32_16x16x32_bf16 v[20:23], v[164:167], v[96:99], v[20:23]
  ds_read_b128 v[64:67], v10 offset:3072
  ds_read_b128 v[68:71], v10 offset:19456
  v_mfma_f32_16x16x32_bf16 v[24:27], v[160:163], v[100:103], v[24:27]
  v_mfma_f32_16x16x32_bf16 v[28:31], v[164:167], v[100:103], v[28:31]
  ds_read_b64_tr_b16 v[160:161], v3 offset:12288
  ds_read_b64_tr_b16 v[162:163], v3 offset:12800
  ds_read_b64_tr_b16 v[164:165], v3 offset:12296
  ds_read_b64_tr_b16 v[166:167], v3 offset:12808
  s_waitcnt lgkmcnt(15)
  v_mfma_f32_16x16x32_bf16 v[16:19], v[104:107], v[40:43], v[16:19]
  v_mfma_f32_16x16x32_bf16 v[20:23], v[108:111], v[40:43], v[20:23]
  ds_read_b128 v[72:75], v11 offset:0
  ds_read_b128 v[76:79], v11 offset:16384
  v_mfma_f32_16x16x32_bf16 v[24:27], v[104:107], v[44:47], v[24:27]
  v_mfma_f32_16x16x32_bf16 v[28:31], v[108:111], v[44:47], v[28:31]
  s_waitcnt lgkmcnt(15)
  v_mfma_f32_16x16x32_bf16 v[16:19], v[112:115], v[48:51], v[16:19]
  v_mfma_f32_16x16x32_bf16 v[20:23], v[116:119], v[48:51], v[20:23]
  ds_read_b128 v[80:83], v11 offset:1024
  ds_read_b128 v[84:87], v11 offset:17408
  v_mfma_f32_16x16x32_bf16 v[24:27], v[112:115], v[52:55], v[24:27]
  v_mfma_f32_16x16x32_bf16 v[28:31], v[116:119], v[52:55], v[28:31]
  s_waitcnt lgkmcnt(14)
  v_mfma_f32_16x16x32_bf16 v[16:19], v[120:123], v[56:59], v[16:19]
  v_mfma_f32_16x16x32_bf16 v[20:23], v[124:127], v[56:59], v[20:23]
  ds_read_b128 v[88:91], v11 offset:2048
  ds_read_b128 v[92:95], v11 offset:18432
  v_mfma_f32_16x16x32_bf16 v[24:27], v[120:123], v[60:63], v[24:27]
  v_mfma_f32_16x16x32_bf16 v[28:31], v[124:127], v[60:63], v[28:31]
  s_waitcnt lgkmcnt(10)
  v_mfma_f32_16x16x32_bf16 v[16:19], v[128:131], v[64:67], v[16:19]
  v_mfma_f32_16x16x32_bf16 v[20:23], v[132:135], v[64:67], v[20:23]
  ds_read_b128 v[96:99], v11 offset:3072
  ds_read_b128 v[100:103], v11 offset:19456
  v_mfma_f32_16x16x32_bf16 v[24:27], v[128:131], v[68:71], v[24:27]
  v_mfma_f32_16x16x32_bf16 v[28:31], v[132:135], v[68:71], v[28:31]
  s_waitcnt lgkmcnt(6)
  v_mfma_f32_16x16x32_bf16 v[16:19], v[136:139], v[72:75], v[16:19]
  v_mfma_f32_16x16x32_bf16 v[20:23], v[140:143], v[72:75], v[20:23]
  v_mfma_f32_16x16x32_bf16 v[24:27], v[136:139], v[76:79], v[24:27]
  v_mfma_f32_16x16x32_bf16 v[28:31], v[140:143], v[76:79], v[28:31]
  s_waitcnt lgkmcnt(4)
  v_mfma_f32_16x16x32_bf16 v[16:19], v[144:147], v[80:83], v[16:19]
  v_mfma_f32_16x16x32_bf16 v[20:23], v[148:151], v[80:83], v[20:23]
  v_mfma_f32_16x16x32_bf16 v[24:27], v[144:147], v[84:87], v[24:27]
  v_mfma_f32_16x16x32_bf16 v[28:31], v[148:151], v[84:87], v[28:31]
  s_waitcnt lgkmcnt(2)
  v_mfma_f32_16x16x32_bf16 v[16:19], v[152:155], v[88:91], v[16:19]
  v_mfma_f32_16x16x32_bf16 v[20:23], v[156:159], v[88:91], v[20:23]
  v_mfma_f32_16x16x32_bf16 v[24:27], v[152:155], v[92:95], v[24:27]
  v_mfma_f32_16x16x32_bf16 v[28:31], v[156:159], v[92:95], v[28:31]
  s_waitcnt lgkmcnt(0)
  v_mfma_f32_16x16x32_bf16 v[16:19], v[160:163], v[96:99], v[16:19]
  v_mfma_f32_16x16x32_bf16 v[20:23], v[164:167], v[96:99], v[20:23]
  v_mfma_f32_16x16x32_bf16 v[24:27], v[160:163], v[100:103], v[24:27]
  v_mfma_f32_16x16x32_bf16 v[28:31], v[164:167], v[100:103], v[28:31]
L_fin:
  s_nop 7
  v_cvt_pk_bf16_f32 v32, v16, v17
  v_cvt_pk_bf16_f32 v33, v18, v19
  v_cvt_pk_bf16_f32 v34, v20, v21
  v_cvt_pk_bf16_f32 v35, v22, v23
  s_add_u32 s57, s70, 0
  buffer_store_dwordx4 v[32:35], v1, s[36:39], s57 offen sc1
  v_cvt_pk_bf16_f32 v36, v24, v25
  v_cvt_pk_bf16_f32 v37, v26, v27
  v_cvt_pk_bf16_f32 v38, v28, v29
  v_cvt_pk_bf16_f32 v39, v30, v31
  s_add_u32 s57, s70, 2048
  buffer_store_dwordx4 v[36:39], v1, s[36:39], s57 offen sc1
L_end:
  s_endpgm
L_codeend:
.section .rodata,"a"
.p2align 6
.amdhsa_kernel concat_heads__sliding_local_dilated__linear_attn_block__prompt_kernel
  .amdhsa_next_free_vgpr 168
  .amdhsa_next_free_sgpr 102
  .amdhsa_accum_offset 168
  .amdhsa_group_segment_fixed_size 0
  .amdhsa_kernarg_size 72
  .amdhsa_user_sgpr_count 2
  .amdhsa_user_sgpr_kernarg_segment_ptr 1
  .amdhsa_system_sgpr_workgroup_id_x 1
.end_amdhsa_kernel
```
